```python
import torch

def _softmax(x, axis=-1):
    return torch.softmax(x, dim=axis)
def _gelu(x):
    return torch.nn.functional.gelu(x, approximate="tanh")
def _silu(x):
    return torch.nn.functional.silu(x)
def _sigmoid(x):
    return torch.sigmoid(x)
def _layernorm(x, axis=-1, eps=1e-5):
    m = x.mean(dim=axis, keepdim=True)
    v = x.var(dim=axis, keepdim=True, unbiased=False)
    return (x - m) / torch.sqrt(v + eps)
def _scatter_add(tgt, idx, src, axis=0):
    return tgt.clone().index_add_(axis, idx, src)
def _segment_sum(src, seg, n):
    out = torch.zeros((n,) + src.shape[1:], dtype=src.dtype)
    return out.index_add_(0, seg, src)
def _pad(x, pw):
    flat = tuple(v for pair in reversed(pw) for v in pair)
    return torch.nn.functional.pad(x, flat)

kernel_name = 'concat_heads__linear_kernel_hedgehog__ssm_conv_s4__prompt'

def setup_inputs():

    _w = (lambda a: (lambda t: t.to(torch.bfloat16) if t.is_floating_point() else t)(torch.as_tensor(a)))
    def _A_setup():
        B, S, D, H = 1, 2048, 1024, 32
        Dh = D // H
        return {
            "x": _w((lambda *s: torch.randn(*s, dtype=torch.bfloat16) * 0.4)(B, S, D)),
            "wqkv": _w((lambda *s: torch.randn(*s, dtype=torch.bfloat16) * 0.4)(D, 3 * D)),
            "w_phi": _w((lambda *s: torch.randn(*s, dtype=torch.bfloat16) * 0.4)(H, Dh, Dh) * (Dh ** -0.5)),
            "wo": _w((lambda *s: torch.randn(*s, dtype=torch.bfloat16) * 0.05)(D, D)),
        }
    _A_in = _A_setup()

    def _B_setup():
        B, L, D, N = 1, 2048, 1024, 128
        A_re = -(lambda _x: torch.exp(torch.as_tensor(_x)))((lambda *s: torch.randn(*s, dtype=torch.bfloat16) * 3.2)(D, N))
        A_im = torch.pi * (lambda *s: torch.randn(*s, dtype=torch.bfloat16) * 0.2)(D, N)
        B_re = (lambda *s: torch.randn(*s, dtype=torch.bfloat16) * 0.8)(D, N)
        B_im = (lambda *s: torch.randn(*s, dtype=torch.bfloat16) * 0.8)(D, N)
        C_re = (lambda *s: torch.randn(*s, dtype=torch.bfloat16) * 0.8)(D, N)
        C_im = (lambda *s: torch.randn(*s, dtype=torch.bfloat16) * 0.8)(D, N)
        log_dt = (lambda *s: torch.randn(*s, dtype=torch.bfloat16) * 0.2)(D) * 0.5 - 4.0
        Dskip = (lambda *s: torch.randn(*s, dtype=torch.bfloat16) * 1.6)(D)
        return {
            "u": _w((lambda *s: torch.randn(*s, dtype=torch.bfloat16) * 0.05)(B, L, D)),
            "A_re": _w(A_re),
            "A_im": _w(A_im),
            "B_re": _w(B_re),
            "B_im": _w(B_im),
            "C_re": _w(C_re),
            "C_im": _w(C_im),
            "log_dt": _w(log_dt),
            "Dskip": _w(Dskip),
        }
    _B_in = _B_setup()

    return {
        "A_x": _A_in["x"],
        "A_wqkv": _A_in["wqkv"],
        "A_w_phi": _A_in["w_phi"],
        "A_wo": _A_in["wo"],
        "B_u": _B_in["u"],
        "B_A_re": _B_in["A_re"],
        "B_A_im": _B_in["A_im"],
        "B_B_re": _B_in["B_re"],
        "B_B_im": _B_in["B_im"],
        "B_C_re": _B_in["C_re"],
        "B_C_im": _B_in["C_im"],
        "B_log_dt": _B_in["log_dt"],
        "B_Dskip": _B_in["Dskip"],
    }

def reference(A_x, A_wqkv, A_w_phi, A_wo, B_u, B_A_re, B_A_im, B_B_re, B_B_im, B_C_re, B_C_im, B_log_dt, B_Dskip):
    def _A_ref(x, wqkv, w_phi, wo):
        B, S, D = x.shape
        H = 32; Dh = D // H
        qkv = (lambda x, *d: x.permute(*d))((x @ wqkv).reshape(B, S, 3, H, Dh), 2, 0, 3, 1, 4)
        q, k, v = qkv[0], qkv[1], qkv[2]
        pq = torch.einsum("bhsd,hdf->bhsf", q, w_phi)
        pk = torch.einsum("bhsd,hdf->bhsf", k, w_phi)
        phi_q = torch.concatenate([_softmax(pq, axis=-1), _softmax(-pq, axis=-1)], axis=-1)
        phi_k = torch.concatenate([_softmax(pk, axis=-1), _softmax(-pk, axis=-1)], axis=-1)
        kv = torch.einsum("bhsf,bhsd->bhfd", phi_k, v)
        z  = torch.einsum("bhsf->bhf", phi_k)
        num = torch.einsum("bhqf,bhfd->bhqd", phi_q, kv)
        den = torch.einsum("bhqf,bhf->bhq", phi_q, z)[..., None] + 1e-6
        o = num / den
        return (lambda x, *d: x.permute(*d))(o, 0, 2, 1, 3).reshape(B, S, D) @ wo

    def _B_ref(u, A_re, A_im, B_re, B_im, C_re, C_im, log_dt, Dskip):
        Bsz, L, D = u.shape
        dt = torch.exp(log_dt)[:, None]
        A = A_re + 1j * A_im
        Bc = B_re + 1j * B_im
        Cc = C_re + 1j * C_im
        logdA = dt * A
        dB = dt * Bc
        l = (lambda x, dt: x.to(dt))(torch.arange(L), A_re.dtype)
        P = torch.exp(logdA[:, :, None] * l[None, None, :])
        K = torch.einsum("dn,dnl,dn->dl", Cc, P, dB).real
        L2 = 2 * L
        Kp = _pad(K, ((0, 0), (0, L)))
        up = (lambda x, *d: x.permute(*d))(u, 0, 2, 1)
        up = _pad(up, ((0, 0), (0, 0), (0, L)))
        Kf = (lambda x, axes=(-2,-1): torch.fft.rfft2(x.float(), dim=axes))(Kp[:, None, :], axes=(-2, -1))
        Uf = (lambda x, axes=(-2,-1): torch.fft.rfft2(x.float(), dim=axes))(up[:, :, None, :], axes=(-2, -1))
        Yf = Uf * Kf[None, :, :, :]
        y = (lambda x, s, axes=(-2,-1): torch.fft.irfft2(x, s=s, dim=axes).to(torch.bfloat16))(Yf, (1, L2), axes=(-2, -1))[:, :, 0, :L]
        y = (lambda x, *d: x.permute(*d))(y, 0, 2, 1) + u * Dskip[None, None, :]
        return y

    a = _A_ref(A_x, A_wqkv, A_w_phi, A_wo)
    b = _B_ref(B_u, B_A_re, B_A_im, B_B_re, B_B_im, B_C_re, B_C_im, B_log_dt, B_Dskip)
    return torch.concatenate([a, b], axis=-1)
```

```asm
; @launch grid=(256,1,1) block=(512,1,1) lds=163840
.amdgcn_target "amdgcn-amd-amdhsa--gfx950"
.text
.globl concat_heads__linear_kernel_hedgehog__ssm_conv_s4__prompt_kernel
.p2align 8
.type concat_heads__linear_kernel_hedgehog__ssm_conv_s4__prompt_kernel,@function
concat_heads__linear_kernel_hedgehog__ssm_conv_s4__prompt_kernel:
    s_cmp_ge_u32 s2, 256
    s_cbranch_scc1 k_end
    s_load_dwordx16 s[4:19], s[0:1], 0
    s_load_dwordx16 s[20:35], s[0:1], 64
    s_and_b32 s36, s2, 7
    s_lshr_b32 s37, s2, 3
    s_and_b32 s38, s36, 3
    s_lshl_b32 s38, s38, 2
    s_and_b32 s39, s37, 3
    s_add_u32 s38, s38, s39
    s_lshr_b32 s39, s36, 2
    s_lshl_b32 s39, s39, 3
    s_lshr_b32 s41, s37, 2
    s_add_u32 s39, s39, s41
    v_lshrrev_b32 v1, 6, v0
    v_and_b32 v0, 63, v0
    v_readfirstlane_b32 s40, v1
    s_lshr_b32 s68, s37, 4
    s_lshl_b32 s69, s36, 1
    s_add_u32 s68, s68, s69
    s_and_b32 s69, s37, 15
    s_mov_b32 s100, s68
    s_add_u32 s101, s69, 2
    s_and_b32 s101, s101, 15
    s_mov_b32 s97, s101
    s_cmp_ge_u32 s40, 4
    s_cbranch_scc1 k_s
    s_and_b32 s42, s40, 1
    s_lshr_b32 s43, s40, 1
    s_lshl_b32 s47, s36, 5
    s_add_u32 s47, s47, s37
    s_lshl_b32 s47, s47, 2
    s_add_u32 s47, s47, s40
    v_and_b32 v8, 31, v0
    s_lshl_b32 s60, s47, 8
    v_lshl_add_u32 v2, v8, 3, s60
    s_lshl_b32 s60, s47, 1
    v_mov_b32 v3, s60
    s_lshl_b32 s44, s38, 1
    s_add_u32 s44, s44, s42
    s_lshl_b32 s45, s44, 1
    s_add_u32 s45, s45, s43
    s_lshl_b32 s45, s45, 10
    v_lshl_add_u32 v4, v0, 4, s45
    s_waitcnt lgkmcnt(0)
    s_add_u32 s0, s34, 15466496
    s_addc_u32 s1, s35, 0
    s_nop 0
    s_load_dword s53, s[0:1], 0
    global_load_ushort v180, v3, s[26:27]
    global_load_dword v168, v2, s[14:15]
    global_load_dword v169, v2, s[16:17]
    global_load_dword v170, v2, s[18:19]
    global_load_dword v171, v2, s[20:21]
    global_load_dword v172, v2, s[22:23]
    global_load_dword v173, v2, s[24:25]
    global_load_dwordx4 v[12:15], v4, s[8:9]
    s_mov_b32 s56, s34
    s_mov_b32 s57, s35
    s_mov_b32 s58, 268435456
    s_mov_b32 s59, 0x20000
    s_mov_b32 s72, 2130706432
    s_lshl_b32 s73, s38, 2
    s_add_u32 s73, s73, s40
    s_lshl_b32 s73, s73, 4
    v_lshrrev_b32 v9, 5, v0
    v_lshlrev_b32 v176, 2, v9
    v_sub_u32 v176, v8, v176
    v_mov_b32 v177, 0x3f80
    v_mov_b32 v178, 0x3f800000
    v_cmp_eq_u32 vcc, 0, v176
    v_cmp_eq_u32 s[98:99], 1, v176
    s_nop 0
    v_cndmask_b32 v160, 0, v177, vcc
    v_cndmask_b32 v160, v160, v178, s[98:99]
    v_cmp_eq_u32 vcc, 2, v176
    v_cmp_eq_u32 s[98:99], 3, v176
    s_nop 0
    v_cndmask_b32 v161, 0, v177, vcc
    v_cndmask_b32 v161, v161, v178, s[98:99]
    v_cmp_eq_u32 vcc, 8, v176
    v_cmp_eq_u32 s[98:99], 9, v176
    s_nop 0
    v_cndmask_b32 v162, 0, v177, vcc
    v_cndmask_b32 v162, v162, v178, s[98:99]
    v_cmp_eq_u32 vcc, 10, v176
    v_cmp_eq_u32 s[98:99], 11, v176
    s_nop 0
    v_cndmask_b32 v163, 0, v177, vcc
    v_cndmask_b32 v163, v163, v178, s[98:99]
    v_cmp_eq_u32 vcc, 16, v176
    v_cmp_eq_u32 s[98:99], 17, v176
    s_nop 0
    v_cndmask_b32 v164, 0, v177, vcc
    v_cndmask_b32 v164, v164, v178, s[98:99]
    v_cmp_eq_u32 vcc, 18, v176
    v_cmp_eq_u32 s[98:99], 19, v176
    s_nop 0
    v_cndmask_b32 v165, 0, v177, vcc
    v_cndmask_b32 v165, v165, v178, s[98:99]
    v_cmp_eq_u32 vcc, 24, v176
    v_cmp_eq_u32 s[98:99], 25, v176
    s_nop 0
    v_cndmask_b32 v166, 0, v177, vcc
    v_cndmask_b32 v166, v166, v178, s[98:99]
    v_cmp_eq_u32 vcc, 26, v176
    v_cmp_eq_u32 s[98:99], 27, v176
    s_nop 0
    v_cndmask_b32 v167, 0, v177, vcc
    v_cndmask_b32 v167, v167, v178, s[98:99]
    s_lshl_b32 s46, s43, 13
    v_bfe_u32 v10, v8, 1, 3
    v_xor_b32 v10, v10, v9
    v_lshl_add_u32 v11, v8, 7, s46
    v_xor_b32 v7, 0, v10
    v_lshl_add_u32 v2, v7, 4, v11
    v_xor_b32 v7, 2, v10
    v_lshl_add_u32 v3, v7, 4, v11
    v_xor_b32 v7, 4, v10
    v_lshl_add_u32 v4, v7, 4, v11
    v_xor_b32 v7, 6, v10
    v_lshl_add_u32 v5, v7, 4, v11
    v_bfe_u32 v10, v0, 2, 2
    v_lshrrev_b32 v11, 1, v10
    v_xor_b32 v11, s42, v11
    v_lshl_add_u32 v7, v9, 3, v10
    v_lshlrev_b32 v7, 7, v7
    v_lshl_add_u32 v7, v11, 6, v7
    v_bfe_u32 v11, v0, 4, 1
    v_lshlrev_b32 v1, 5, v11
    v_and_b32 v11, 3, v0
    v_lshl_add_u32 v1, v11, 3, v1
    v_add_u32 v7, v7, v1
    v_add_u32 v6, 16384, v7
    v_lshl_add_u32 v10, v9, 2, v10
    v_lshl_add_u32 v1, v10, 6, v1
    s_lshl_b32 s60, s42, 11
    s_add_u32 s60, s60, 122880
    v_add_u32 v1, s60, v1
    v_cmp_eq_u32 s[70:71], 1, v9
    v_mov_b32 v224, 0
    v_mov_b32 v225, 0
    v_mov_b32 v226, 0
    v_mov_b32 v227, 0
    v_mov_b32 v228, 0
    v_mov_b32 v229, 0
    v_mov_b32 v230, 0
    v_mov_b32 v231, 0
    v_mov_b32 v232, 0
    v_mov_b32 v233, 0
    v_mov_b32 v234, 0
    v_mov_b32 v235, 0
    v_mov_b32 v236, 0
    v_mov_b32 v237, 0
    v_mov_b32 v238, 0
    v_mov_b32 v239, 0
    v_mov_b32 v16, 0
    v_mov_b32 v17, 0
    v_mov_b32 v18, 0
    v_mov_b32 v19, 0
    v_mov_b32 v20, 0
    v_mov_b32 v21, 0
    v_mov_b32 v22, 0
    v_mov_b32 v23, 0
    v_mov_b32 v24, 0
    v_mov_b32 v25, 0
    v_mov_b32 v26, 0
    v_mov_b32 v27, 0
    v_mov_b32 v28, 0
    v_mov_b32 v29, 0
    v_mov_b32 v30, 0
    v_mov_b32 v31, 0
    v_mov_b32 v32, 0
    v_mov_b32 v33, 0
    v_mov_b32 v34, 0
    v_mov_b32 v35, 0
    v_mov_b32 v36, 0
    v_mov_b32 v37, 0
    v_mov_b32 v38, 0
    v_mov_b32 v39, 0
    v_mov_b32 v40, 0
    v_mov_b32 v41, 0
    v_mov_b32 v42, 0
    v_mov_b32 v43, 0
    v_mov_b32 v44, 0
    v_mov_b32 v45, 0
    v_mov_b32 v46, 0
    v_mov_b32 v47, 0
    v_mov_b32 v80, 0
    v_mov_b32 v81, 0
    v_mov_b32 v82, 0
    v_mov_b32 v83, 0
    v_mov_b32 v84, 0
    v_mov_b32 v85, 0
    v_mov_b32 v86, 0
    v_mov_b32 v87, 0
    v_mov_b32 v88, 0
    v_mov_b32 v89, 0
    v_mov_b32 v90, 0
    v_mov_b32 v91, 0
    v_mov_b32 v92, 0
    v_mov_b32 v93, 0
    v_mov_b32 v94, 0
    v_mov_b32 v95, 0
    v_mov_b32 v96, 0
    v_mov_b32 v97, 0
    v_mov_b32 v98, 0
    v_mov_b32 v99, 0
    v_mov_b32 v100, 0
    v_mov_b32 v101, 0
    v_mov_b32 v102, 0
    v_mov_b32 v103, 0
    v_mov_b32 v104, 0
    v_mov_b32 v105, 0
    v_mov_b32 v106, 0
    v_mov_b32 v107, 0
    v_mov_b32 v108, 0
    v_mov_b32 v109, 0
    v_mov_b32 v110, 0
    v_mov_b32 v111, 0
    s_lshl_b32 s60, s42, 1
    s_add_u32 s60, s60, s43
    s_lshl_b32 s60, s60, 10
    s_add_u32 s60, s60, 122880
    v_lshl_add_u32 v10, v0, 4, s60
    s_lshl_b32 s60, s40, 12
    s_add_u32 s60, s60, 143360
    v_lshl_add_u32 v11, v0, 4, s60
    s_mul_i32 s47, s43, 0x80008000
    s_waitcnt vmcnt(1)
    s_waitcnt lgkmcnt(0)
    v_lshlrev_b32 v180, 16, v180
    s_mov_b32 s78, 0x3fb8aa3b
    v_mul_f32 v186, s78, v180
    v_fma_f32 v187, v180, s78, -v186
    v_fmac_f32 v187, 0x32a57060, v180
    v_exp_f32 v186, v186
    v_mul_f32 v187, 0x3f317218, v187
    v_fma_f32 v186, v186, v187, v186
    v_cvt_pk_bf16_f32 v182, v186, v186
    v_lshlrev_b32 v182, 16, v182
    s_mov_b32 s46, 0
k_g_kgen:
    v_lshlrev_b32 v184, 16, v168
    v_mfma_f32_32x32x16_bf16 v[112:127], v[64:67], v[164:167], v[112:127]
    v_lshlrev_b32 v185, 16, v169
    v_lshlrev_b32 v206, 16, v170
    v_lshlrev_b32 v207, 16, v171
    v_lshlrev_b32 v208, 16, v172
    v_lshlrev_b32 v209, 16, v173
    v_mul_f32 v184, v184, v182
    v_mfma_f32_32x32x16_bf16 v[128:143], v[68:71], v[164:167], v[128:143]
    v_mul_f32 v185, v185, v182
    v_mul_f32 v184, 0x3fb8aa3b, v184
    v_mul_f32 v185, 0x3e22f983, v185
    v_exp_f32 v186, v184
    v_fract_f32 v187, v185
    v_cos_f32 v188, v187
    v_sin_f32 v189, v187
    v_mfma_f32_32x32x16_bf16 v[144:159], v[72:75], v[164:167], v[144:159]
    v_lshrrev_b32 v168, 16, v168
    v_lshrrev_b32 v169, 16, v169
    v_mul_f32 v188, v188, v186
    v_mul_f32 v189, v189, v186
    v_mul_f32 v186, 0x43800000, v184
    v_mul_f32 v187, 0x43800000, v185
    v_mfma_f32_32x32x16_bf16 v[48:63], v[76:79], v[164:167], v[48:63]
    v_exp_f32 v186, v186
    v_fract_f32 v187, v187
    v_cos_f32 v190, v187
    v_sin_f32 v191, v187
    v_lshrrev_b32 v170, 16, v170
    v_lshrrev_b32 v171, 16, v171
    v_mul_f32 v190, v190, v186
    v_mul_f32 v191, v191, v186
    v_lshrrev_b32 v172, 16, v172
    v_lshrrev_b32 v173, 16, v173
    s_cmp_eq_u32 s46, 0
    s_cbranch_scc1 k_g_kfirst
    s_nop 0
    v_cvt_pk_bf16_f32 v112, v112, v128
    v_cvt_pk_bf16_f32 v113, v113, v129
    v_cvt_pk_bf16_f32 v114, v114, v130
    v_cvt_pk_bf16_f32 v115, v115, v131
    v_cvt_pk_bf16_f32 v144, v144, v48
    v_cvt_pk_bf16_f32 v145, v145, v49
    v_cvt_pk_bf16_f32 v146, v146, v50
    v_cvt_pk_bf16_f32 v147, v147, v51
    v_cvt_pk_bf16_f32 v116, v116, v132
    v_cvt_pk_bf16_f32 v117, v117, v133
    v_mfma_f32_32x32x16_bf16 v[224:239], v[112:115], v[144:147], v[224:239]
    v_cvt_pk_bf16_f32 v118, v118, v134
    v_cvt_pk_bf16_f32 v119, v119, v135
    v_cvt_pk_bf16_f32 v148, v148, v52
    v_cvt_pk_bf16_f32 v149, v149, v53
    v_cvt_pk_bf16_f32 v150, v150, v54
    v_cvt_pk_bf16_f32 v151, v151, v55
    v_cvt_pk_bf16_f32 v120, v120, v136
    v_cvt_pk_bf16_f32 v121, v121, v137
    v_mfma_f32_32x32x16_bf16 v[224:239], v[116:119], v[148:151], v[224:239]
    v_cvt_pk_bf16_f32 v122, v122, v138
    v_cvt_pk_bf16_f32 v123, v123, v139
    v_cvt_pk_bf16_f32 v152, v152, v56
    v_cvt_pk_bf16_f32 v153, v153, v57
    v_cvt_pk_bf16_f32 v154, v154, v58
    v_cvt_pk_bf16_f32 v155, v155, v59
    v_cvt_pk_bf16_f32 v124, v124, v140
    v_cvt_pk_bf16_f32 v125, v125, v141
    v_mfma_f32_32x32x16_bf16 v[224:239], v[120:123], v[152:155], v[224:239]
    v_cvt_pk_bf16_f32 v126, v126, v142
    v_cvt_pk_bf16_f32 v127, v127, v143
    v_cvt_pk_bf16_f32 v156, v156, v60
    v_cvt_pk_bf16_f32 v157, v157, v61
    v_cvt_pk_bf16_f32 v158, v158, v62
    v_cvt_pk_bf16_f32 v159, v159, v63
    s_nop 1
    s_nop 0
    v_mfma_f32_32x32x16_bf16 v[224:239], v[124:127], v[156:159], v[224:239]
k_g_kfirst:
    v_pk_mul_f32 v[192:193], v[188:189], v[188:189] op_sel_hi:[1,0]
    v_pk_mul_f32 v[204:205], v[206:207], v[208:209] op_sel_hi:[1,0]
    v_pk_fma_f32 v[192:193], v[188:189], v[188:189], v[192:193] op_sel:[1,1,0] op_sel_hi:[0,1,1] neg_lo:[1,0,0]
    v_pk_fma_f32 v[204:205], v[206:207], v[208:209], v[204:205] op_sel:[1,1,0] op_sel_hi:[0,1,1] neg_lo:[1,0,0]
    v_pk_mul_f32 v[194:195], v[192:193], v[192:193] op_sel_hi:[1,0]
    v_mul_f32 v204, v204, v182
    v_pk_fma_f32 v[194:195], v[192:193], v[192:193], v[194:195] op_sel:[1,1,0] op_sel_hi:[0,1,1] neg_lo:[1,0,0]
    v_mul_f32 v205, v205, v182
    v_pk_mul_f32 v[196:197], v[194:195], v[194:195] op_sel_hi:[1,0]
    v_cndmask_b32 v202, 1.0, v194, s[70:71]
    v_pk_fma_f32 v[196:197], v[194:195], v[194:195], v[196:197] op_sel:[1,1,0] op_sel_hi:[0,1,1] neg_lo:[1,0,0]
    v_cndmask_b32 v203, 0, v195, s[70:71]
    v_pk_mul_f32 v[200:201], v[196:197], v[196:197] op_sel_hi:[1,0]
    v_pk_mul_f32 v[206:207], v[204:205], v[202:203] op_sel_hi:[1,0]
    v_pk_fma_f32 v[200:201], v[196:197], v[196:197], v[200:201] op_sel:[1,1,0] op_sel_hi:[0,1,1] neg_lo:[1,0,0]
    v_pk_fma_f32 v[206:207], v[204:205], v[202:203], v[206:207] op_sel:[1,1,0] op_sel_hi:[0,1,1] neg_lo:[1,0,0]
    v_pk_mul_f32 v[198:199], v[200:201], v[200:201] op_sel_hi:[1,0]
    v_pk_mul_f32 v[208:209], v[206:207], v[188:189] op_sel_hi:[1,0]
    v_pk_fma_f32 v[198:199], v[200:201], v[200:201], v[198:199] op_sel:[1,1,0] op_sel_hi:[0,1,1] neg_lo:[1,0,0]
    v_pk_fma_f32 v[208:209], v[206:207], v[188:189], v[208:209] op_sel:[1,1,0] op_sel_hi:[0,1,1] neg_lo:[1,0,0]
    v_pk_mul_f32 v[200:201], v[198:199], v[196:197] op_sel_hi:[1,0]
    v_pk_mul_f32 v[210:211], v[208:209], v[188:189] op_sel_hi:[1,0]
    v_pk_fma_f32 v[200:201], v[198:199], v[196:197], v[200:201] op_sel:[1,1,0] op_sel_hi:[0,1,1] neg_lo:[1,0,0]
    v_pk_fma_f32 v[210:211], v[208:209], v[188:189], v[210:211] op_sel:[1,1,0] op_sel_hi:[0,1,1] neg_lo:[1,0,0]
    v_cndmask_b32 v216, 1.0, v198, s[70:71]
    v_cndmask_b32 v217, 0, v199, s[70:71]
    v_cvt_pk_bf16_f32 v240, v206, v208
    v_cvt_pk_bf16_f32 v244, -v207, -v209
    v_pk_mul_f32 v[218:219], v[216:217], v[196:197] op_sel_hi:[1,0]
    s_nop 0
    v_pk_fma_f32 v[218:219], v[216:217], v[196:197], v[218:219] op_sel:[1,1,0] op_sel_hi:[0,1,1] neg_lo:[1,0,0]
    s_nop 0
    v_cvt_pk_bf16_f32 v248, v216, v218
    v_cvt_pk_bf16_f32 v252, v217, v219
    v_pk_mul_f32 v[216:217], v[218:219], v[196:197] op_sel_hi:[1,0]
    s_nop 0
    s_nop 0
    v_pk_fma_f32 v[216:217], v[218:219], v[196:197], v[216:217] op_sel:[1,1,0] op_sel_hi:[0,1,1] neg_lo:[1,0,0]
    v_pk_mul_f32 v[212:213], v[210:211], v[188:189] op_sel_hi:[1,0]
    v_pk_mul_f32 v[218:219], v[216:217], v[196:197] op_sel_hi:[1,0]
    v_pk_fma_f32 v[212:213], v[210:211], v[188:189], v[212:213] op_sel:[1,1,0] op_sel_hi:[0,1,1] neg_lo:[1,0,0]
    v_pk_fma_f32 v[218:219], v[216:217], v[196:197], v[218:219] op_sel:[1,1,0] op_sel_hi:[0,1,1] neg_lo:[1,0,0]
    v_cvt_pk_bf16_f32 v241, v210, v212
    v_cvt_pk_bf16_f32 v245, -v211, -v213
    v_cvt_pk_bf16_f32 v249, v216, v218
    v_cvt_pk_bf16_f32 v253, v217, v219
    v_pk_mul_f32 v[208:209], v[206:207], v[190:191] op_sel_hi:[1,0]
    v_pk_mul_f32 v[216:217], v[218:219], v[200:201] op_sel_hi:[1,0]
    v_pk_fma_f32 v[208:209], v[206:207], v[190:191], v[208:209] op_sel:[1,1,0] op_sel_hi:[0,1,1] neg_lo:[1,0,0]
    v_pk_fma_f32 v[216:217], v[218:219], v[200:201], v[216:217] op_sel:[1,1,0] op_sel_hi:[0,1,1] neg_lo:[1,0,0]
    v_pk_mul_f32 v[210:211], v[208:209], v[192:193] op_sel_hi:[1,0]
    v_pk_mul_f32 v[218:219], v[216:217], v[196:197] op_sel_hi:[1,0]
    v_pk_fma_f32 v[210:211], v[208:209], v[192:193], v[210:211] op_sel:[1,1,0] op_sel_hi:[0,1,1] neg_lo:[1,0,0]
    v_pk_fma_f32 v[218:219], v[216:217], v[196:197], v[218:219] op_sel:[1,1,0] op_sel_hi:[0,1,1] neg_lo:[1,0,0]
    v_cvt_pk_bf16_f32 v242, v208, v210
    v_cvt_pk_bf16_f32 v246, -v209, -v211
    v_cvt_pk_bf16_f32 v250, v216, v218
    v_cvt_pk_bf16_f32 v254, v217, v219
    v_pk_mul_f32 v[212:213], v[210:211], v[192:193] op_sel_hi:[1,0]
    v_pk_mul_f32 v[216:217], v[218:219], v[196:197] op_sel_hi:[1,0]
    v_pk_fma_f32 v[212:213], v[210:211], v[192:193], v[212:213] op_sel:[1,1,0] op_sel_hi:[0,1,1] neg_lo:[1,0,0]
    v_pk_fma_f32 v[216:217], v[218:219], v[196:197], v[216:217] op_sel:[1,1,0] op_sel_hi:[0,1,1] neg_lo:[1,0,0]
    v_pk_mul_f32 v[214:215], v[190:191], v[202:203] op_sel_hi:[1,0]
    v_pk_mul_f32 v[218:219], v[216:217], v[196:197] op_sel_hi:[1,0]
    v_pk_fma_f32 v[214:215], v[190:191], v[202:203], v[214:215] op_sel:[1,1,0] op_sel_hi:[0,1,1] neg_lo:[1,0,0]
    v_pk_fma_f32 v[218:219], v[216:217], v[196:197], v[218:219] op_sel:[1,1,0] op_sel_hi:[0,1,1] neg_lo:[1,0,0]
    v_cvt_pk_bf16_f32 v243, v212, v212
    v_cvt_pk_bf16_f32 v247, -v213, -v213
    v_cvt_pk_bf16_f32 v251, v216, v218
    v_cvt_pk_bf16_f32 v255, v217, v219
    v_pk_mul_f32 v[206:207], v[208:209], v[190:191] op_sel_hi:[1,0]
    v_pk_mul_f32 v[216:217], v[218:219], v[200:201] op_sel_hi:[1,0]
    v_pk_fma_f32 v[206:207], v[208:209], v[190:191], v[206:207] op_sel:[1,1,0] op_sel_hi:[0,1,1] neg_lo:[1,0,0]
    v_pk_fma_f32 v[216:217], v[218:219], v[200:201], v[216:217] op_sel:[1,1,0] op_sel_hi:[0,1,1] neg_lo:[1,0,0]
    v_pk_mul_f32 v[210:211], v[206:207], v[194:195] op_sel_hi:[1,0]
    v_pk_mul_f32 v[218:219], v[216:217], v[196:197] op_sel_hi:[1,0]
    v_pk_fma_f32 v[210:211], v[206:207], v[194:195], v[210:211] op_sel:[1,1,0] op_sel_hi:[0,1,1] neg_lo:[1,0,0]
    v_pk_fma_f32 v[218:219], v[216:217], v[196:197], v[218:219] op_sel:[1,1,0] op_sel_hi:[0,1,1] neg_lo:[1,0,0]
    v_mfma_f32_32x32x16_bf16 v[112:127], v[240:243], v[160:163], 0
    v_cvt_pk_bf16_f32 v64, v206, v210
    v_cvt_pk_bf16_f32 v68, -v207, -v211
    v_cvt_pk_bf16_f32 v72, v216, v218
    v_cvt_pk_bf16_f32 v76, v217, v219
    v_pk_mul_f32 v[208:209], v[206:207], v[190:191] op_sel_hi:[1,0]
    v_pk_mul_f32 v[216:217], v[218:219], v[196:197] op_sel_hi:[1,0]
    v_pk_fma_f32 v[208:209], v[206:207], v[190:191], v[208:209] op_sel:[1,1,0] op_sel_hi:[0,1,1] neg_lo:[1,0,0]
    v_pk_fma_f32 v[216:217], v[218:219], v[196:197], v[216:217] op_sel:[1,1,0] op_sel_hi:[0,1,1] neg_lo:[1,0,0]
    v_pk_mul_f32 v[212:213], v[208:209], v[194:195] op_sel_hi:[1,0]
    v_pk_mul_f32 v[218:219], v[216:217], v[196:197] op_sel_hi:[1,0]
    v_pk_fma_f32 v[212:213], v[208:209], v[194:195], v[212:213] op_sel:[1,1,0] op_sel_hi:[0,1,1] neg_lo:[1,0,0]
    v_pk_fma_f32 v[218:219], v[216:217], v[196:197], v[218:219] op_sel:[1,1,0] op_sel_hi:[0,1,1] neg_lo:[1,0,0]
    v_mfma_f32_32x32x16_bf16 v[128:143], v[244:247], v[160:163], 0
    v_cvt_pk_bf16_f32 v65, v208, v212
    v_cvt_pk_bf16_f32 v69, -v209, -v213
    v_cvt_pk_bf16_f32 v73, v216, v218
    v_cvt_pk_bf16_f32 v77, v217, v219
    v_pk_mul_f32 v[206:207], v[208:209], v[214:215] op_sel_hi:[1,0]
    v_pk_mul_f32 v[216:217], v[218:219], v[200:201] op_sel_hi:[1,0]
    v_pk_fma_f32 v[206:207], v[208:209], v[214:215], v[206:207] op_sel:[1,1,0] op_sel_hi:[0,1,1] neg_lo:[1,0,0]
    v_pk_fma_f32 v[216:217], v[218:219], v[200:201], v[216:217] op_sel:[1,1,0] op_sel_hi:[0,1,1] neg_lo:[1,0,0]
    v_pk_mul_f32 v[210:211], v[206:207], v[190:191] op_sel_hi:[1,0]
    v_pk_mul_f32 v[218:219], v[216:217], v[196:197] op_sel_hi:[1,0]
    v_pk_fma_f32 v[210:211], v[206:207], v[190:191], v[210:211] op_sel:[1,1,0] op_sel_hi:[0,1,1] neg_lo:[1,0,0]
    v_pk_fma_f32 v[218:219], v[216:217], v[196:197], v[218:219] op_sel:[1,1,0] op_sel_hi:[0,1,1] neg_lo:[1,0,0]
    v_mfma_f32_32x32x16_bf16 v[144:159], v[248:251], v[160:163], 0
    v_cvt_pk_bf16_f32 v66, v206, v210
    v_cvt_pk_bf16_f32 v70, -v207, -v211
    v_cvt_pk_bf16_f32 v74, v216, v218
    v_cvt_pk_bf16_f32 v78, v217, v219
    v_pk_mul_f32 v[208:209], v[210:211], v[190:191] op_sel_hi:[1,0]
    v_pk_mul_f32 v[216:217], v[218:219], v[196:197] op_sel_hi:[1,0]
    v_pk_fma_f32 v[208:209], v[210:211], v[190:191], v[208:209] op_sel:[1,1,0] op_sel_hi:[0,1,1] neg_lo:[1,0,0]
    v_pk_fma_f32 v[216:217], v[218:219], v[196:197], v[216:217] op_sel:[1,1,0] op_sel_hi:[0,1,1] neg_lo:[1,0,0]
    v_pk_mul_f32 v[212:213], v[208:209], v[190:191] op_sel_hi:[1,0]
    v_pk_mul_f32 v[218:219], v[216:217], v[196:197] op_sel_hi:[1,0]
    v_pk_fma_f32 v[212:213], v[208:209], v[190:191], v[212:213] op_sel:[1,1,0] op_sel_hi:[0,1,1] neg_lo:[1,0,0]
    v_pk_fma_f32 v[218:219], v[216:217], v[196:197], v[218:219] op_sel:[1,1,0] op_sel_hi:[0,1,1] neg_lo:[1,0,0]
    v_mfma_f32_32x32x16_bf16 v[48:63], v[252:255], v[160:163], 0
    v_cvt_pk_bf16_f32 v67, v208, v212
    v_cvt_pk_bf16_f32 v71, -v209, -v213
    v_cvt_pk_bf16_f32 v75, v216, v218
    v_cvt_pk_bf16_f32 v79, v217, v219
    s_add_u32 s46, s46, 1
    s_cmp_lt_u32 s46, 2
    s_cbranch_scc1 k_g_kgen
    v_mfma_f32_32x32x16_bf16 v[112:127], v[64:67], v[164:167], v[112:127]
    v_mfma_f32_32x32x16_bf16 v[128:143], v[68:71], v[164:167], v[128:143]
    s_waitcnt vmcnt(0)
    ds_write_b128 v10, v[12:15]
    s_add_u32 s53, s53, 1
    v_mfma_f32_32x32x16_bf16 v[144:159], v[72:75], v[164:167], v[144:159]
    v_mfma_f32_32x32x16_bf16 v[48:63], v[76:79], v[164:167], v[48:63]
    s_nop 6
    v_cvt_pk_bf16_f32 v112, v112, v128
    v_cvt_pk_bf16_f32 v113, v113, v129
    v_cvt_pk_bf16_f32 v114, v114, v130
    v_cvt_pk_bf16_f32 v115, v115, v131
    s_nop 0
    s_nop 0
    v_cvt_pk_bf16_f32 v144, v144, v48
    v_cvt_pk_bf16_f32 v145, v145, v49
    v_cvt_pk_bf16_f32 v146, v146, v50
    v_cvt_pk_bf16_f32 v147, v147, v51
    v_cvt_pk_bf16_f32 v116, v116, v132
    v_cvt_pk_bf16_f32 v117, v117, v133
    v_mfma_f32_32x32x16_bf16 v[224:239], v[112:115], v[144:147], v[224:239]
    v_cvt_pk_bf16_f32 v118, v118, v134
    v_cvt_pk_bf16_f32 v119, v119, v135
    v_cvt_pk_bf16_f32 v148, v148, v52
    v_cvt_pk_bf16_f32 v149, v149, v53
    v_cvt_pk_bf16_f32 v150, v150, v54
    v_cvt_pk_bf16_f32 v151, v151, v55
    v_cvt_pk_bf16_f32 v120, v120, v136
    v_cvt_pk_bf16_f32 v121, v121, v137
    v_mfma_f32_32x32x16_bf16 v[224:239], v[116:119], v[148:151], v[224:239]
    v_cvt_pk_bf16_f32 v122, v122, v138
    v_cvt_pk_bf16_f32 v123, v123, v139
    v_cvt_pk_bf16_f32 v152, v152, v56
    v_cvt_pk_bf16_f32 v153, v153, v57
    v_cvt_pk_bf16_f32 v154, v154, v58
    v_cvt_pk_bf16_f32 v155, v155, v59
    v_cvt_pk_bf16_f32 v124, v124, v140
    v_cvt_pk_bf16_f32 v125, v125, v141
    v_mfma_f32_32x32x16_bf16 v[224:239], v[120:123], v[152:155], v[224:239]
    v_cvt_pk_bf16_f32 v126, v126, v142
    v_cvt_pk_bf16_f32 v127, v127, v143
    v_cvt_pk_bf16_f32 v156, v156, v60
    v_cvt_pk_bf16_f32 v157, v157, v61
    v_cvt_pk_bf16_f32 v158, v158, v62
    v_cvt_pk_bf16_f32 v159, v159, v63
    s_nop 1
    v_mfma_f32_32x32x16_bf16 v[224:239], v[124:127], v[156:159], v[224:239]
    v_mov_b32 v48, 0
    v_mov_b32 v49, 0
    v_mov_b32 v50, 0
    v_mov_b32 v51, 0
    v_mov_b32 v52, 0
    v_mov_b32 v53, 0
    v_mov_b32 v54, 0
    v_mov_b32 v55, 0
    v_mov_b32 v56, 0
    v_mov_b32 v57, 0
    v_mov_b32 v58, 0
    v_mov_b32 v59, 0
    v_mov_b32 v60, 0
    v_mov_b32 v61, 0
    v_mov_b32 v62, 0
    v_mov_b32 v63, 0
    v_mov_b32 v64, 0
    v_mov_b32 v65, 0
    v_mov_b32 v66, 0
    v_mov_b32 v67, 0
    v_mov_b32 v68, 0
    v_mov_b32 v69, 0
    v_mov_b32 v70, 0
    v_mov_b32 v71, 0
    v_mov_b32 v72, 0
    v_mov_b32 v73, 0
    v_mov_b32 v74, 0
    v_mov_b32 v75, 0
    v_mov_b32 v76, 0
    v_mov_b32 v77, 0
    v_mov_b32 v78, 0
    v_mov_b32 v79, 0
    ds_write_b128 v11, v[224:227] offset:0
    ds_write_b128 v11, v[228:231] offset:1024
    ds_write_b128 v11, v[232:235] offset:2048
    ds_write_b128 v11, v[236:239] offset:3072
    s_waitcnt lgkmcnt(0)
    s_mov_b32 s50, 0
    s_mov_b32 s51, 0
    s_barrier
    s_nop 0
    ds_read_b64_tr_b16 v[152:153], v1 offset:0
    ds_read_b64_tr_b16 v[154:155], v1 offset:512
    ds_read_b64_tr_b16 v[156:157], v1 offset:1024
    ds_read_b64_tr_b16 v[158:159], v1 offset:1536
    ds_read_b128 v[112:115], v2
    ds_read_b64_tr_b16 v[120:121], v6 offset:0
    ds_read_b64_tr_b16 v[122:123], v6 offset:512
    ds_read_b128 v[116:119], v2 offset:4096
    ds_read_b64_tr_b16 v[124:125], v6 offset:2048
    ds_read_b64_tr_b16 v[126:127], v6 offset:2560
    ds_read_b64_tr_b16 v[128:129], v6 offset:4096
    ds_read_b64_tr_b16 v[130:131], v6 offset:4608
    s_waitcnt lgkmcnt(8)
    v_xor_b32 v152, s47, v152
    v_xor_b32 v153, s47, v153
    v_xor_b32 v154, s47, v154
    v_xor_b32 v155, s47, v155
    v_xor_b32 v156, s47, v156
    v_xor_b32 v157, s47, v157
    v_xor_b32 v158, s47, v158
    v_xor_b32 v159, s47, v159
k_gloop:
    s_waitcnt lgkmcnt(5)
    v_mfma_f32_32x32x16_bf16 v[16:31], v[120:123], v[112:115], v[16:31]
    ds_read_b128 v[132:135], v3
    ds_read_b64_tr_b16 v[140:141], v6 offset:6144
    s_waitcnt lgkmcnt(6)
    v_mfma_f32_32x32x16_bf16 v[32:47], v[120:123], v[116:119], v[32:47]
    ds_read_b64_tr_b16 v[142:143], v6 offset:6656
    ds_read_b128 v[136:139], v3 offset:4096
    s_waitcnt lgkmcnt(6)
    v_mfma_f32_32x32x16_bf16 v[48:63], v[124:127], v[112:115], v[48:63]
    ds_read_b64_tr_b16 v[144:145], v6 offset:8192
    ds_read_b64_tr_b16 v[146:147], v6 offset:8704
    v_mfma_f32_32x32x16_bf16 v[64:79], v[124:127], v[116:119], v[64:79]
    ds_read_b64_tr_b16 v[148:149], v6 offset:10240
    ds_read_b64_tr_b16 v[150:151], v6 offset:10752
    s_waitcnt lgkmcnt(8)
    v_mfma_f32_32x32x16_bf16 v[80:95], v[112:115], v[128:131], v[80:95]
    v_mfma_f32_32x32x16_bf16 v[96:111], v[116:119], v[128:131], v[96:111]
    s_waitcnt lgkmcnt(5)
    v_mfma_f32_32x32x16_bf16 v[16:31], v[140:143], v[132:135], v[16:31]
    ds_read_b128 v[112:115], v4
    ds_read_b64_tr_b16 v[120:121], v6 offset:12288
    s_waitcnt lgkmcnt(6)
    v_mfma_f32_32x32x16_bf16 v[32:47], v[140:143], v[136:139], v[32:47]
    ds_read_b64_tr_b16 v[122:123], v6 offset:12800
    ds_read_b128 v[116:119], v4 offset:4096
    s_waitcnt lgkmcnt(6)
    v_mfma_f32_32x32x16_bf16 v[48:63], v[144:147], v[132:135], v[48:63]
    ds_read_b64_tr_b16 v[124:125], v6 offset:14336
    ds_read_b64_tr_b16 v[126:127], v6 offset:14848
    v_mfma_f32_32x32x16_bf16 v[64:79], v[144:147], v[136:139], v[64:79]
    ds_read_b64_tr_b16 v[128:129], v6 offset:16384
    ds_read_b64_tr_b16 v[130:131], v6 offset:16896
    s_waitcnt lgkmcnt(8)
    v_mfma_f32_32x32x16_bf16 v[80:95], v[132:135], v[148:151], v[80:95]
    v_mfma_f32_32x32x16_bf16 v[96:111], v[136:139], v[148:151], v[96:111]
    s_waitcnt lgkmcnt(5)
    v_mfma_f32_32x32x16_bf16 v[16:31], v[120:123], v[112:115], v[16:31]
    ds_read_b128 v[132:135], v5
    ds_read_b64_tr_b16 v[140:141], v6 offset:18432
    s_waitcnt lgkmcnt(6)
    v_mfma_f32_32x32x16_bf16 v[32:47], v[120:123], v[116:119], v[32:47]
    ds_read_b64_tr_b16 v[142:143], v6 offset:18944
    ds_read_b128 v[136:139], v5 offset:4096
    s_waitcnt lgkmcnt(6)
    v_mfma_f32_32x32x16_bf16 v[48:63], v[124:127], v[112:115], v[48:63]
    ds_read_b64_tr_b16 v[144:145], v6 offset:20480
    ds_read_b64_tr_b16 v[146:147], v6 offset:20992
    v_mfma_f32_32x32x16_bf16 v[64:79], v[124:127], v[116:119], v[64:79]
    ds_read_b64_tr_b16 v[148:149], v6 offset:22528
    ds_read_b64_tr_b16 v[150:151], v6 offset:23040
    s_waitcnt lgkmcnt(8)
    v_mfma_f32_32x32x16_bf16 v[80:95], v[112:115], v[128:131], v[80:95]
    s_cmp_eq_u32 s50, 15
    v_mfma_f32_32x32x16_bf16 v[96:111], v[116:119], v[128:131], v[96:111]
    s_waitcnt lgkmcnt(0)
    s_cbranch_scc1 k_nobar
    s_barrier
k_nobar:
    s_add_u32 s51, s51, 1
    s_mov_b32 s52, 40960
    s_cmp_eq_u32 s51, 3
    s_cselect_b32 s52, 4294885376, s52
    s_cselect_b32 s51, 0, s51
    v_mfma_f32_32x32x16_bf16 v[16:31], v[140:143], v[132:135], v[16:31]
    v_add_u32 v2, s52, v2
    v_add_u32 v6, s52, v6
    ds_read_b128 v[112:115], v2
    ds_read_b64_tr_b16 v[120:121], v6 offset:0
    v_mfma_f32_32x32x16_bf16 v[32:47], v[140:143], v[136:139], v[32:47]
    ds_read_b64_tr_b16 v[122:123], v6 offset:512
    ds_read_b128 v[116:119], v2 offset:4096
    v_mfma_f32_32x32x16_bf16 v[48:63], v[144:147], v[132:135], v[48:63]
    ds_read_b64_tr_b16 v[124:125], v6 offset:2048
    ds_read_b64_tr_b16 v[126:127], v6 offset:2560
    v_mfma_f32_32x32x16_bf16 v[64:79], v[144:147], v[136:139], v[64:79]
    ds_read_b64_tr_b16 v[128:129], v6 offset:4096
    ds_read_b64_tr_b16 v[130:131], v6 offset:4608
    v_mfma_f32_32x32x16_bf16 v[80:95], v[132:135], v[148:151], v[80:95]
    v_add_u32 v3, s52, v3
    v_add_u32 v4, s52, v4
    v_add_u32 v5, s52, v5
    s_add_u32 s50, s50, 1
    s_cmp_lt_u32 s50, 16
    v_mfma_f32_32x32x16_bf16 v[96:111], v[136:139], v[148:151], v[96:111]
    s_cbranch_scc1 k_gloop
    s_waitcnt lgkmcnt(0)
    s_setprio 3
    v_mov_b32 v1, 77740
    v_mov_b32 v7, 1
    s_mov_b64 exec, 1
    ds_add_u32 v1, v7
    s_mov_b64 exec, -1
    s_nop 0
    s_mov_b32 s54, 0x3fb8aa3b
    s_mov_b32 s55, 0x3fb8aa3b
    v_cvt_pk_bf16_f32 v112, v48, v49
    v_cvt_pk_bf16_f32 v113, v50, v51
    v_cvt_pk_bf16_f32 v114, v52, v53
    v_cvt_pk_bf16_f32 v115, v54, v55
    v_cvt_pk_bf16_f32 v116, v56, v57
    v_cvt_pk_bf16_f32 v117, v58, v59
    v_cvt_pk_bf16_f32 v118, v60, v61
    v_cvt_pk_bf16_f32 v119, v62, v63
    v_cvt_pk_bf16_f32 v120, v64, v65
    v_mfma_f32_32x32x16_bf16 v[168:183], v[152:155], v[112:115], 0
    v_cvt_pk_bf16_f32 v121, v66, v67
    v_cvt_pk_bf16_f32 v122, v68, v69
    v_cvt_pk_bf16_f32 v123, v70, v71
    v_cvt_pk_bf16_f32 v124, v72, v73
    v_cvt_pk_bf16_f32 v125, v74, v75
    v_cvt_pk_bf16_f32 v126, v76, v77
    v_cvt_pk_bf16_f32 v127, v78, v79
    v_mfma_f32_32x32x16_bf16 v[168:183], v[156:159], v[116:119], v[168:183]
    v_cvt_pk_bf16_f32 v128, v80, v81
    v_mfma_f32_32x32x16_bf16 v[184:199], v[152:155], v[120:123], 0
    v_cvt_pk_bf16_f32 v129, v82, v83
    v_cvt_pk_bf16_f32 v130, v84, v85
    v_cvt_pk_bf16_f32 v131, v86, v87
    v_cvt_pk_bf16_f32 v132, v88, v89
    v_cvt_pk_bf16_f32 v133, v90, v91
    v_cvt_pk_bf16_f32 v134, v92, v93
    v_cvt_pk_bf16_f32 v135, v94, v95
    v_cvt_pk_bf16_f32 v136, v96, v97
    v_mfma_f32_32x32x16_bf16 v[184:199], v[156:159], v[124:127], v[184:199]
    v_cvt_pk_bf16_f32 v137, v98, v99
    v_cvt_pk_bf16_f32 v138, v100, v101
    v_cvt_pk_bf16_f32 v139, v102, v103
    v_cvt_pk_bf16_f32 v140, v104, v105
    v_cvt_pk_bf16_f32 v141, v106, v107
    v_cvt_pk_bf16_f32 v142, v108, v109
    v_cvt_pk_bf16_f32 v143, v110, v111
    v_mov_b32 v8, 0x3f803f80
    v_mov_b32 v9, 0x3f803f80
    v_mov_b32 v10, 0x3f803f80
    v_mov_b32 v11, 0x3f803f80
    s_mul_i32 s60, s40, 4352
    s_add_u32 s60, s60, 77824
    s_xor_b32 s61, s40, 2
    s_nop 0
    s_mul_i32 s61, s61, 4352
    s_add_u32 s61, s61, 77824
    v_max3_f32 v232, v168, v169, v170
    v_max3_f32 v236, v184, v185, v186
    v_max3_f32 v234, -v168, -v169, -v170
    v_max3_f32 v238, -v184, -v185, -v186
    v_max3_f32 v232, v232, v171, v172
    v_max3_f32 v236, v236, v187, v188
    v_max3_f32 v234, v234, -v171, -v172
    v_max3_f32 v238, v238, -v187, -v188
    v_max3_f32 v232, v232, v173, v174
    v_max3_f32 v236, v236, v189, v190
    v_max3_f32 v234, v234, -v173, -v174
    v_max3_f32 v238, v238, -v189, -v190
    v_max3_f32 v232, v232, v175, v176
    v_max3_f32 v236, v236, v191, v192
    v_max3_f32 v234, v234, -v175, -v176
    v_max3_f32 v238, v238, -v191, -v192
    v_max3_f32 v232, v232, v177, v178
    v_max3_f32 v236, v236, v193, v194
    v_max3_f32 v234, v234, -v177, -v178
    v_max3_f32 v238, v238, -v193, -v194
    v_max3_f32 v232, v232, v179, v180
    v_max3_f32 v236, v236, v195, v196
    v_max3_f32 v234, v234, -v179, -v180
    v_max3_f32 v238, v238, -v195, -v196
    v_max3_f32 v232, v232, v181, v182
    v_max3_f32 v236, v236, v197, v198
    v_max3_f32 v234, v234, -v181, -v182
    v_max3_f32 v238, v238, -v197, -v198
    v_max_f32 v232, v232, v183
    v_max_f32 v236, v236, v199
    v_max_f32_e64 v234, v234, -v183
    v_max_f32_e64 v238, v238, -v199
    s_nop 0
    v_permlane32_swap_b32 v232, v234
    v_permlane32_swap_b32 v236, v238
    v_max_f32 v232, v232, v234
    v_max_f32 v236, v236, v238
    v_mul_f32 v232, 0xbfb8aa3b, v232
    v_mul_f32 v236, 0xbfb8aa3b, v236
    v_mov_b32 v234, v232
    v_mov_b32 v238, v236
    s_nop 0
    v_permlane32_swap_b32 v232, v234
    v_permlane32_swap_b32 v236, v238
    v_pk_fma_f32 v[200:201], v[168:169], s[54:55], v[234:235] op_sel_hi:[1,1,0] neg_lo:[1,0,0] neg_hi:[1,0,0]
    v_pk_fma_f32 v[216:217], v[184:185], s[54:55], v[238:239] op_sel_hi:[1,1,0] neg_lo:[1,0,0] neg_hi:[1,0,0]
    v_pk_fma_f32 v[168:169], v[168:169], s[54:55], v[232:233] op_sel_hi:[1,1,0]
    v_pk_fma_f32 v[184:185], v[184:185], s[54:55], v[236:237] op_sel_hi:[1,1,0]
    v_pk_fma_f32 v[202:203], v[170:171], s[54:55], v[234:235] op_sel_hi:[1,1,0] neg_lo:[1,0,0] neg_hi:[1,0,0]
    v_pk_fma_f32 v[218:219], v[186:187], s[54:55], v[238:239] op_sel_hi:[1,1,0] neg_lo:[1,0,0] neg_hi:[1,0,0]
    v_pk_fma_f32 v[170:171], v[170:171], s[54:55], v[232:233] op_sel_hi:[1,1,0]
    v_pk_fma_f32 v[186:187], v[186:187], s[54:55], v[236:237] op_sel_hi:[1,1,0]
    v_pk_fma_f32 v[204:205], v[172:173], s[54:55], v[234:235] op_sel_hi:[1,1,0] neg_lo:[1,0,0] neg_hi:[1,0,0]
    v_pk_fma_f32 v[220:221], v[188:189], s[54:55], v[238:239] op_sel_hi:[1,1,0] neg_lo:[1,0,0] neg_hi:[1,0,0]
    v_pk_fma_f32 v[172:173], v[172:173], s[54:55], v[232:233] op_sel_hi:[1,1,0]
    v_pk_fma_f32 v[188:189], v[188:189], s[54:55], v[236:237] op_sel_hi:[1,1,0]
    v_pk_fma_f32 v[206:207], v[174:175], s[54:55], v[234:235] op_sel_hi:[1,1,0] neg_lo:[1,0,0] neg_hi:[1,0,0]
    v_pk_fma_f32 v[222:223], v[190:191], s[54:55], v[238:239] op_sel_hi:[1,1,0] neg_lo:[1,0,0] neg_hi:[1,0,0]
    v_pk_fma_f32 v[174:175], v[174:175], s[54:55], v[232:233] op_sel_hi:[1,1,0]
    v_pk_fma_f32 v[190:191], v[190:191], s[54:55], v[236:237] op_sel_hi:[1,1,0]
    v_pk_fma_f32 v[208:209], v[176:177], s[54:55], v[234:235] op_sel_hi:[1,1,0] neg_lo:[1,0,0] neg_hi:[1,0,0]
    v_pk_fma_f32 v[224:225], v[192:193], s[54:55], v[238:239] op_sel_hi:[1,1,0] neg_lo:[1,0,0] neg_hi:[1,0,0]
    v_pk_fma_f32 v[176:177], v[176:177], s[54:55], v[232:233] op_sel_hi:[1,1,0]
    v_pk_fma_f32 v[192:193], v[192:193], s[54:55], v[236:237] op_sel_hi:[1,1,0]
    v_pk_fma_f32 v[210:211], v[178:179], s[54:55], v[234:235] op_sel_hi:[1,1,0] neg_lo:[1,0,0] neg_hi:[1,0,0]
    v_pk_fma_f32 v[226:227], v[194:195], s[54:55], v[238:239] op_sel_hi:[1,1,0] neg_lo:[1,0,0] neg_hi:[1,0,0]
    v_pk_fma_f32 v[178:179], v[178:179], s[54:55], v[232:233] op_sel_hi:[1,1,0]
    v_pk_fma_f32 v[194:195], v[194:195], s[54:55], v[236:237] op_sel_hi:[1,1,0]
    v_pk_fma_f32 v[212:213], v[180:181], s[54:55], v[234:235] op_sel_hi:[1,1,0] neg_lo:[1,0,0] neg_hi:[1,0,0]
    v_pk_fma_f32 v[228:229], v[196:197], s[54:55], v[238:239] op_sel_hi:[1,1,0] neg_lo:[1,0,0] neg_hi:[1,0,0]
    v_pk_fma_f32 v[180:181], v[180:181], s[54:55], v[232:233] op_sel_hi:[1,1,0]
    v_pk_fma_f32 v[196:197], v[196:197], s[54:55], v[236:237] op_sel_hi:[1,1,0]
    v_pk_fma_f32 v[214:215], v[182:183], s[54:55], v[234:235] op_sel_hi:[1,1,0] neg_lo:[1,0,0] neg_hi:[1,0,0]
    v_pk_fma_f32 v[230:231], v[198:199], s[54:55], v[238:239] op_sel_hi:[1,1,0] neg_lo:[1,0,0] neg_hi:[1,0,0]
    v_pk_fma_f32 v[182:183], v[182:183], s[54:55], v[232:233] op_sel_hi:[1,1,0]
    v_pk_fma_f32 v[198:199], v[198:199], s[54:55], v[236:237] op_sel_hi:[1,1,0]
    v_exp_f32 v200, v200
    v_exp_f32 v216, v216
    v_exp_f32 v168, v168
    v_exp_f32 v184, v184
    v_exp_f32 v201, v201
    v_exp_f32 v217, v217
    v_exp_f32 v169, v169
    v_exp_f32 v185, v185
    v_exp_f32 v202, v202
    v_exp_f32 v218, v218
    v_exp_f32 v170, v170
    v_exp_f32 v186, v186
    v_exp_f32 v203, v203
    v_exp_f32 v219, v219
    v_exp_f32 v171, v171
    v_exp_f32 v187, v187
    v_exp_f32 v204, v204
    v_exp_f32 v220, v220
    v_exp_f32 v172, v172
    v_exp_f32 v188, v188
    v_exp_f32 v205, v205
    v_exp_f32 v221, v221
    v_exp_f32 v173, v173
    v_exp_f32 v189, v189
    v_exp_f32 v206, v206
    v_exp_f32 v222, v222
    v_exp_f32 v174, v174
    v_exp_f32 v190, v190
    v_exp_f32 v207, v207
    v_exp_f32 v223, v223
    v_exp_f32 v175, v175
    v_exp_f32 v191, v191
    v_exp_f32 v208, v208
    v_exp_f32 v224, v224
    v_exp_f32 v176, v176
    v_exp_f32 v192, v192
    v_exp_f32 v209, v209
    v_exp_f32 v225, v225
    v_exp_f32 v177, v177
    v_exp_f32 v193, v193
    v_exp_f32 v210, v210
    v_exp_f32 v226, v226
    v_exp_f32 v178, v178
    v_exp_f32 v194, v194
    v_exp_f32 v211, v211
    v_exp_f32 v227, v227
    v_exp_f32 v179, v179
    v_exp_f32 v195, v195
    v_exp_f32 v212, v212
    v_exp_f32 v228, v228
    v_exp_f32 v180, v180
    v_exp_f32 v196, v196
    v_exp_f32 v213, v213
    v_exp_f32 v229, v229
    v_exp_f32 v181, v181
    v_exp_f32 v197, v197
    v_exp_f32 v214, v214
    v_exp_f32 v230, v230
    v_exp_f32 v182, v182
    v_exp_f32 v198, v198
    v_exp_f32 v215, v215
    v_exp_f32 v231, v231
    v_exp_f32 v183, v183
    v_exp_f32 v199, v199
    v_pk_add_f32 v[234:235], v[200:201], v[202:203]
    v_pk_add_f32 v[238:239], v[216:217], v[218:219]
    v_pk_add_f32 v[232:233], v[168:169], v[170:171]
    v_pk_add_f32 v[236:237], v[184:185], v[186:187]
    v_pk_add_f32 v[234:235], v[234:235], v[204:205]
    v_pk_add_f32 v[238:239], v[238:239], v[220:221]
    v_pk_add_f32 v[232:233], v[232:233], v[172:173]
    v_pk_add_f32 v[236:237], v[236:237], v[188:189]
    v_pk_add_f32 v[234:235], v[234:235], v[206:207]
    v_pk_add_f32 v[238:239], v[238:239], v[222:223]
    v_pk_add_f32 v[232:233], v[232:233], v[174:175]
    v_pk_add_f32 v[236:237], v[236:237], v[190:191]
    v_pk_add_f32 v[234:235], v[234:235], v[208:209]
    v_pk_add_f32 v[238:239], v[238:239], v[224:225]
    v_pk_add_f32 v[232:233], v[232:233], v[176:177]
    v_pk_add_f32 v[236:237], v[236:237], v[192:193]
    v_pk_add_f32 v[234:235], v[234:235], v[210:211]
    v_pk_add_f32 v[238:239], v[238:239], v[226:227]
    v_pk_add_f32 v[232:233], v[232:233], v[178:179]
    v_pk_add_f32 v[236:237], v[236:237], v[194:195]
    v_pk_add_f32 v[234:235], v[234:235], v[212:213]
    v_pk_add_f32 v[238:239], v[238:239], v[228:229]
    v_pk_add_f32 v[232:233], v[232:233], v[180:181]
    v_pk_add_f32 v[236:237], v[236:237], v[196:197]
    v_pk_add_f32 v[234:235], v[234:235], v[214:215]
    v_pk_add_f32 v[238:239], v[238:239], v[230:231]
    v_pk_add_f32 v[232:233], v[232:233], v[182:183]
    v_pk_add_f32 v[236:237], v[236:237], v[198:199]
    v_add_f32 v234, v234, v235
    v_add_f32 v238, v238, v239
    v_add_f32 v232, v232, v233
    v_add_f32 v236, v236, v237
    s_nop 0
    v_permlane32_swap_b32 v232, v234
    v_permlane32_swap_b32 v236, v238
    v_add_f32 v232, v232, v234
    v_add_f32 v236, v236, v238
    v_rcp_f32 v232, v232
    v_rcp_f32 v236, v236
    v_mov_b32 v234, v232
    v_mov_b32 v238, v236
    s_nop 0
    v_permlane32_swap_b32 v232, v234
    v_permlane32_swap_b32 v236, v238
    v_pk_mul_f32 v[200:201], v[200:201], v[234:235] op_sel_hi:[1,0]
    v_pk_mul_f32 v[202:203], v[202:203], v[234:235] op_sel_hi:[1,0]
    v_pk_mul_f32 v[204:205], v[204:205], v[234:235] op_sel_hi:[1,0]
    v_pk_mul_f32 v[206:207], v[206:207], v[234:235] op_sel_hi:[1,0]
    v_pk_mul_f32 v[208:209], v[208:209], v[234:235] op_sel_hi:[1,0]
    v_pk_mul_f32 v[210:211], v[210:211], v[234:235] op_sel_hi:[1,0]
    v_pk_mul_f32 v[212:213], v[212:213], v[234:235] op_sel_hi:[1,0]
    v_pk_mul_f32 v[214:215], v[214:215], v[234:235] op_sel_hi:[1,0]
    v_cvt_pk_bf16_f32 v56, v200, v201
    v_cvt_pk_bf16_f32 v57, v202, v203
    v_cvt_pk_bf16_f32 v58, v204, v205
    v_cvt_pk_bf16_f32 v59, v206, v207
    v_cvt_pk_bf16_f32 v60, v208, v209
    v_cvt_pk_bf16_f32 v61, v210, v211
    v_cvt_pk_bf16_f32 v62, v212, v213
    v_cvt_pk_bf16_f32 v63, v214, v215
    v_pk_mul_f32 v[168:169], v[168:169], v[232:233] op_sel_hi:[1,0]
    v_pk_mul_f32 v[170:171], v[170:171], v[232:233] op_sel_hi:[1,0]
    v_pk_mul_f32 v[172:173], v[172:173], v[232:233] op_sel_hi:[1,0]
    v_mfma_f32_32x32x16_bf16 v[200:215], v[56:59], v[160:163], 0
    v_pk_mul_f32 v[174:175], v[174:175], v[232:233] op_sel_hi:[1,0]
    v_pk_mul_f32 v[176:177], v[176:177], v[232:233] op_sel_hi:[1,0]
    v_pk_mul_f32 v[178:179], v[178:179], v[232:233] op_sel_hi:[1,0]
    v_pk_mul_f32 v[180:181], v[180:181], v[232:233] op_sel_hi:[1,0]
    v_pk_mul_f32 v[182:183], v[182:183], v[232:233] op_sel_hi:[1,0]
    v_cvt_pk_bf16_f32 v48, v168, v169
    v_cvt_pk_bf16_f32 v49, v170, v171
    v_mfma_f32_32x32x16_bf16 v[200:215], v[60:63], v[164:167], v[200:215]
    v_cvt_pk_bf16_f32 v50, v172, v173
    v_cvt_pk_bf16_f32 v51, v174, v175
    v_cvt_pk_bf16_f32 v52, v176, v177
    v_cvt_pk_bf16_f32 v53, v178, v179
    v_cvt_pk_bf16_f32 v54, v180, v181
    v_cvt_pk_bf16_f32 v55, v182, v183
    v_pk_mul_f32 v[216:217], v[216:217], v[238:239] op_sel_hi:[1,0]
    v_pk_mul_f32 v[218:219], v[218:219], v[238:239] op_sel_hi:[1,0]
    v_pk_mul_f32 v[220:221], v[220:221], v[238:239] op_sel_hi:[1,0]
    v_mfma_f32_32x32x16_bf16 v[168:183], v[48:51], v[160:163], 0
    v_pk_mul_f32 v[222:223], v[222:223], v[238:239] op_sel_hi:[1,0]
    v_pk_mul_f32 v[224:225], v[224:225], v[238:239] op_sel_hi:[1,0]
    v_pk_mul_f32 v[226:227], v[226:227], v[238:239] op_sel_hi:[1,0]
    v_pk_mul_f32 v[228:229], v[228:229], v[238:239] op_sel_hi:[1,0]
    v_pk_mul_f32 v[230:231], v[230:231], v[238:239] op_sel_hi:[1,0]
    v_cvt_pk_bf16_f32 v72, v216, v217
    v_cvt_pk_bf16_f32 v73, v218, v219
    v_mfma_f32_32x32x16_bf16 v[168:183], v[52:55], v[164:167], v[168:183]
    v_cvt_pk_bf16_f32 v74, v220, v221
    v_cvt_pk_bf16_f32 v75, v222, v223
    v_cvt_pk_bf16_f32 v76, v224, v225
    v_cvt_pk_bf16_f32 v77, v226, v227
    v_cvt_pk_bf16_f32 v78, v228, v229
    v_cvt_pk_bf16_f32 v79, v230, v231
    v_pk_mul_f32 v[184:185], v[184:185], v[236:237] op_sel_hi:[1,0]
    v_pk_mul_f32 v[186:187], v[186:187], v[236:237] op_sel_hi:[1,0]
    v_pk_mul_f32 v[188:189], v[188:189], v[236:237] op_sel_hi:[1,0]
    v_mfma_f32_32x32x16_bf16 v[216:231], v[72:75], v[160:163], 0
    v_pk_mul_f32 v[190:191], v[190:191], v[236:237] op_sel_hi:[1,0]
    v_pk_mul_f32 v[192:193], v[192:193], v[236:237] op_sel_hi:[1,0]
    v_pk_mul_f32 v[194:195], v[194:195], v[236:237] op_sel_hi:[1,0]
    v_pk_mul_f32 v[196:197], v[196:197], v[236:237] op_sel_hi:[1,0]
    v_pk_mul_f32 v[198:199], v[198:199], v[236:237] op_sel_hi:[1,0]
    v_cvt_pk_bf16_f32 v64, v184, v185
    v_cvt_pk_bf16_f32 v65, v186, v187
    v_mfma_f32_32x32x16_bf16 v[216:231], v[76:79], v[164:167], v[216:231]
    v_cvt_pk_bf16_f32 v66, v188, v189
    v_cvt_pk_bf16_f32 v67, v190, v191
    v_cvt_pk_bf16_f32 v68, v192, v193
    v_cvt_pk_bf16_f32 v69, v194, v195
    v_cvt_pk_bf16_f32 v70, v196, v197
    v_cvt_pk_bf16_f32 v71, v198, v199
    v_cvt_pk_bf16_f32 v120, v200, v201
    v_cvt_pk_bf16_f32 v121, v202, v203
    v_cvt_pk_bf16_f32 v122, v204, v205
    v_mfma_f32_32x32x16_bf16 v[184:199], v[64:67], v[160:163], 0
    v_cvt_pk_bf16_f32 v123, v206, v207
    v_cvt_pk_bf16_f32 v124, v208, v209
    v_cvt_pk_bf16_f32 v125, v210, v211
    v_cvt_pk_bf16_f32 v126, v212, v213
    v_cvt_pk_bf16_f32 v127, v214, v215
    v_cvt_pk_bf16_f32 v112, v168, v169
    v_cvt_pk_bf16_f32 v113, v170, v171
    v_mfma_f32_32x32x16_bf16 v[184:199], v[68:71], v[164:167], v[184:199]
    v_cvt_pk_bf16_f32 v114, v172, v173
    v_cvt_pk_bf16_f32 v115, v174, v175
    v_cvt_pk_bf16_f32 v116, v176, v177
    v_cvt_pk_bf16_f32 v117, v178, v179
    v_cvt_pk_bf16_f32 v118, v180, v181
    v_cvt_pk_bf16_f32 v119, v182, v183
    v_cvt_pk_bf16_f32 v56, v216, v217
    v_mfma_f32_32x32x16_bf16 v[96:111], v[120:123], v[128:131], 0
    v_cvt_pk_bf16_f32 v57, v218, v219
    v_cvt_pk_bf16_f32 v58, v220, v221
    v_cvt_pk_bf16_f32 v59, v222, v223
    v_cvt_pk_bf16_f32 v60, v224, v225
    v_mfma_f32_32x32x16_bf16 v[96:111], v[124:127], v[132:135], v[96:111]
    v_cvt_pk_bf16_f32 v61, v226, v227
    v_cvt_pk_bf16_f32 v62, v228, v229
    v_cvt_pk_bf16_f32 v63, v230, v231
    v_cvt_pk_bf16_f32 v48, v184, v185
    v_mfma_f32_32x32x16_bf16 v[96:111], v[56:59], v[136:139], v[96:111]
    v_cvt_pk_bf16_f32 v49, v186, v187
    v_cvt_pk_bf16_f32 v50, v188, v189
    v_cvt_pk_bf16_f32 v51, v190, v191
    v_cvt_pk_bf16_f32 v52, v192, v193
    v_mfma_f32_32x32x16_bf16 v[96:111], v[60:63], v[140:143], v[96:111]
    v_cvt_pk_bf16_f32 v53, v194, v195
    v_cvt_pk_bf16_f32 v54, v196, v197
    v_cvt_pk_bf16_f32 v55, v198, v199
    v_lshl_add_u32 v12, v0, 4, s60
    v_lshl_add_u32 v13, v0, 4, s61
    v_mfma_f32_32x32x16_bf16 v[200:215], v[8:11], v[120:123], 0
    v_lshl_add_u32 v14, v0, 2, s60
    v_lshl_add_u32 v15, v0, 2, s61
    v_lshlrev_b32 v5, 4, v0
    v_lshlrev_b32 v6, 2, v0
    v_mfma_f32_32x32x16_bf16 v[200:215], v[8:11], v[124:127], v[200:215]
    v_cmp_gt_u32 vcc, 32, v0
    v_mov_b32 v4, 2130706432
    s_nop 0
    v_cndmask_b32 v4, v4, v6, vcc
    v_mfma_f32_32x32x16_bf16 v[200:215], v[8:11], v[56:59], v[200:215]
    v_mfma_f32_32x32x16_bf16 v[200:215], v[8:11], v[60:63], v[200:215]
    v_mfma_f32_32x32x16_bf16 v[80:95], v[112:115], v[128:131], 0
    v_mfma_f32_32x32x16_bf16 v[80:95], v[116:119], v[132:135], v[80:95]
    s_lshl_b32 s62, s42, 2
    s_add_u32 s62, s62, 77728
    s_add_u32 s67, s73, s39
    s_lshl_b32 s74, s67, 11
    s_add_u32 s74, s74, 12582912
    s_lshl_b32 s75, s67, 7
    s_nop 0
    s_add_u32 s75, s75, 14680064
    ds_write_b128 v12, v[96:99] offset:0
    v_mfma_f32_32x32x16_bf16 v[80:95], v[48:51], v[136:139], v[80:95]
    ds_write_b128 v12, v[100:103] offset:1024
    v_mfma_f32_32x32x16_bf16 v[80:95], v[52:55], v[140:143], v[80:95]
    ds_write_b128 v12, v[104:107] offset:2048
    v_mfma_f32_32x32x16_bf16 v[168:183], v[8:11], v[112:115], 0
    ds_write_b128 v12, v[108:111] offset:3072
    v_mfma_f32_32x32x16_bf16 v[168:183], v[8:11], v[116:119], v[168:183]
    ds_write_b32 v14, v200 offset:4096
    v_mfma_f32_32x32x16_bf16 v[168:183], v[8:11], v[48:51], v[168:183]
    v_mfma_f32_32x32x16_bf16 v[168:183], v[8:11], v[52:55], v[168:183]
    s_waitcnt lgkmcnt(0)
    v_mov_b32 v1, s62
    v_mov_b32 v7, 1
    s_mov_b64 exec, 1
    ds_add_u32 v1, v7
    s_mov_b64 exec, -1
    v_mov_b32 v1, s62
    s_mov_b32 s79, 1048576
k_spinA:
    ds_read_b32 v7, v1
    s_sub_u32 s79, s79, 1
    s_cbranch_scc1 k_spinA_x
    s_waitcnt lgkmcnt(0)
    v_readfirstlane_b32 s78, v7
    s_nop 1
    s_cmp_ge_u32 s78, 2
    s_cbranch_scc1 k_spinA_x
    s_branch k_spinA
k_spinA_x:
    s_waitcnt lgkmcnt(0)
    s_nop 0
    ds_read_b128 v[96:99], v13 offset:0
    ds_read_b128 v[100:103], v13 offset:1024
    ds_read_b128 v[104:107], v13 offset:2048
    ds_read_b128 v[108:111], v13 offset:3072
    ds_read_b32 v200, v15 offset:4096
    s_waitcnt lgkmcnt(4)
    v_add_f32 v80, v80, v96
    v_add_f32 v81, v81, v97
    v_add_f32 v82, v82, v98
    v_add_f32 v83, v83, v99
    v_cvt_pk_bf16_f32 v128, v80, v81
    v_cvt_pk_bf16_f32 v129, v82, v83
    s_waitcnt lgkmcnt(3)
    v_add_f32 v84, v84, v100
    v_add_f32 v85, v85, v101
    v_add_f32 v86, v86, v102
    v_add_f32 v87, v87, v103
    v_cvt_pk_bf16_f32 v130, v84, v85
    v_cvt_pk_bf16_f32 v131, v86, v87
    buffer_store_dwordx4 v[128:131], v5, s[56:59], s74 offen offset:0 sc1
    s_waitcnt lgkmcnt(2)
    v_add_f32 v88, v88, v104
    v_add_f32 v89, v89, v105
    v_add_f32 v90, v90, v106
    v_add_f32 v91, v91, v107
    v_cvt_pk_bf16_f32 v132, v88, v89
    v_cvt_pk_bf16_f32 v133, v90, v91
    s_waitcnt lgkmcnt(1)
    v_add_f32 v92, v92, v108
    v_add_f32 v93, v93, v109
    v_add_f32 v94, v94, v110
    v_add_f32 v95, v95, v111
    v_cvt_pk_bf16_f32 v134, v92, v93
    v_cvt_pk_bf16_f32 v135, v94, v95
    buffer_store_dwordx4 v[132:135], v5, s[56:59], s74 offen offset:1024 sc1
    s_waitcnt lgkmcnt(0)
    v_add_f32 v2, v168, v200
    buffer_store_dword v2, v4, s[56:59], s75 offen sc1
    v_cvt_pk_bf16_f32 v112, v16, v17
    v_cvt_pk_bf16_f32 v113, v18, v19
    v_cvt_pk_bf16_f32 v114, v20, v21
    v_cvt_pk_bf16_f32 v115, v22, v23
    v_cvt_pk_bf16_f32 v116, v24, v25
    v_cvt_pk_bf16_f32 v117, v26, v27
    v_cvt_pk_bf16_f32 v118, v28, v29
    v_cvt_pk_bf16_f32 v119, v30, v31
    v_cvt_pk_bf16_f32 v120, v32, v33
    v_cvt_pk_bf16_f32 v121, v34, v35
    v_mfma_f32_32x32x16_bf16 v[168:183], v[152:155], v[112:115], 0
    v_cvt_pk_bf16_f32 v122, v36, v37
    v_cvt_pk_bf16_f32 v123, v38, v39
    v_cvt_pk_bf16_f32 v124, v40, v41
    v_mfma_f32_32x32x16_bf16 v[168:183], v[156:159], v[116:119], v[168:183]
    v_cvt_pk_bf16_f32 v125, v42, v43
    v_cvt_pk_bf16_f32 v126, v44, v45
    v_cvt_pk_bf16_f32 v127, v46, v47
    v_mfma_f32_32x32x16_bf16 v[184:199], v[152:155], v[120:123], 0
    s_nop 0
    v_mfma_f32_32x32x16_bf16 v[184:199], v[156:159], v[124:127], v[184:199]
    v_mov_b32 v64, v160
    v_mov_b32 v65, v161
    v_mov_b32 v66, v162
    v_mov_b32 v67, v163
    v_mov_b32 v68, v164
    v_mov_b32 v69, v165
    v_mov_b32 v70, v166
    v_mov_b32 v71, v167
    s_lshl_b32 s75, s73, 7
    s_add_u32 s75, s75, 14680064
    s_lshl_b32 s76, s38, 11
    s_add_u32 s76, s76, 14942208
    s_lshl_b32 s77, s39, 7
    s_add_u32 s77, s77, s76
    s_nop 0
    v_max3_f32 v232, v168, v169, v170
    v_max3_f32 v236, v184, v185, v186
    v_max3_f32 v234, -v168, -v169, -v170
    v_max3_f32 v238, -v184, -v185, -v186
    v_max3_f32 v232, v232, v171, v172
    v_max3_f32 v236, v236, v187, v188
    v_max3_f32 v234, v234, -v171, -v172
    v_max3_f32 v238, v238, -v187, -v188
    v_max3_f32 v232, v232, v173, v174
    v_max3_f32 v236, v236, v189, v190
    v_max3_f32 v234, v234, -v173, -v174
    v_max3_f32 v238, v238, -v189, -v190
    v_max3_f32 v232, v232, v175, v176
    v_max3_f32 v236, v236, v191, v192
    v_max3_f32 v234, v234, -v175, -v176
    v_max3_f32 v238, v238, -v191, -v192
    v_max3_f32 v232, v232, v177, v178
    v_max3_f32 v236, v236, v193, v194
    v_max3_f32 v234, v234, -v177, -v178
    v_max3_f32 v238, v238, -v193, -v194
    v_max3_f32 v232, v232, v179, v180
    v_max3_f32 v236, v236, v195, v196
    v_max3_f32 v234, v234, -v179, -v180
    v_max3_f32 v238, v238, -v195, -v196
    v_max3_f32 v232, v232, v181, v182
    v_max3_f32 v236, v236, v197, v198
    v_max3_f32 v234, v234, -v181, -v182
    v_max3_f32 v238, v238, -v197, -v198
    v_max_f32 v232, v232, v183
    v_max_f32 v236, v236, v199
    v_max_f32_e64 v234, v234, -v183
    v_max_f32_e64 v238, v238, -v199
    s_nop 0
    v_permlane32_swap_b32 v232, v234
    v_permlane32_swap_b32 v236, v238
    v_max_f32 v232, v232, v234
    v_max_f32 v236, v236, v238
    v_mul_f32 v232, 0xbfb8aa3b, v232
    v_mul_f32 v236, 0xbfb8aa3b, v236
    v_mov_b32 v234, v232
    v_mov_b32 v238, v236
    s_waitcnt vmcnt(0)
    v_mov_b32 v1, 77764
    v_mov_b32 v7, 1
    s_mov_b64 exec, 1
    ds_add_rtn_u32 v7, v1, v7
    s_mov_b64 exec, -1
    s_waitcnt lgkmcnt(0)
    v_readfirstlane_b32 s78, v7
    s_nop 1
    s_cmp_lg_u32 s78, 3
    s_cbranch_scc1 k_ksig
    v_mov_b32 v72, s53
    v_mov_b32 v73, s53
    v_mov_b32 v74, s53
    v_mov_b32 v75, s53
    s_mov_b64 exec, 0xff
    buffer_store_dwordx4 v[72:75], v5, s[56:59], s77 offen sc1
    s_mov_b64 exec, -1
k_ksig:
    v_permlane32_swap_b32 v232, v234
    v_permlane32_swap_b32_e64 v236, v238
    v_pk_fma_f32 v[200:201], v[168:169], s[54:55], v[234:235] op_sel_hi:[1,1,0] neg_lo:[1,0,0] neg_hi:[1,0,0]
    v_pk_fma_f32 v[216:217], v[184:185], s[54:55], v[238:239] op_sel_hi:[1,1,0] neg_lo:[1,0,0] neg_hi:[1,0,0]
    v_pk_fma_f32 v[168:169], v[168:169], s[54:55], v[232:233] op_sel_hi:[1,1,0]
    v_pk_fma_f32 v[184:185], v[184:185], s[54:55], v[236:237] op_sel_hi:[1,1,0]
    v_pk_fma_f32 v[202:203], v[170:171], s[54:55], v[234:235] op_sel_hi:[1,1,0] neg_lo:[1,0,0] neg_hi:[1,0,0]
    v_pk_fma_f32 v[218:219], v[186:187], s[54:55], v[238:239] op_sel_hi:[1,1,0] neg_lo:[1,0,0] neg_hi:[1,0,0]
    v_pk_fma_f32 v[170:171], v[170:171], s[54:55], v[232:233] op_sel_hi:[1,1,0]
    v_pk_fma_f32 v[186:187], v[186:187], s[54:55], v[236:237] op_sel_hi:[1,1,0]
    v_pk_fma_f32 v[204:205], v[172:173], s[54:55], v[234:235] op_sel_hi:[1,1,0] neg_lo:[1,0,0] neg_hi:[1,0,0]
    v_pk_fma_f32 v[220:221], v[188:189], s[54:55], v[238:239] op_sel_hi:[1,1,0] neg_lo:[1,0,0] neg_hi:[1,0,0]
    v_pk_fma_f32 v[172:173], v[172:173], s[54:55], v[232:233] op_sel_hi:[1,1,0]
    v_pk_fma_f32 v[188:189], v[188:189], s[54:55], v[236:237] op_sel_hi:[1,1,0]
    v_pk_fma_f32 v[206:207], v[174:175], s[54:55], v[234:235] op_sel_hi:[1,1,0] neg_lo:[1,0,0] neg_hi:[1,0,0]
    v_pk_fma_f32 v[222:223], v[190:191], s[54:55], v[238:239] op_sel_hi:[1,1,0] neg_lo:[1,0,0] neg_hi:[1,0,0]
    v_pk_fma_f32 v[174:175], v[174:175], s[54:55], v[232:233] op_sel_hi:[1,1,0]
    v_pk_fma_f32 v[190:191], v[190:191], s[54:55], v[236:237] op_sel_hi:[1,1,0]
    v_pk_fma_f32 v[208:209], v[176:177], s[54:55], v[234:235] op_sel_hi:[1,1,0] neg_lo:[1,0,0] neg_hi:[1,0,0]
    v_pk_fma_f32 v[224:225], v[192:193], s[54:55], v[238:239] op_sel_hi:[1,1,0] neg_lo:[1,0,0] neg_hi:[1,0,0]
    v_pk_fma_f32 v[176:177], v[176:177], s[54:55], v[232:233] op_sel_hi:[1,1,0]
    v_pk_fma_f32 v[192:193], v[192:193], s[54:55], v[236:237] op_sel_hi:[1,1,0]
    v_pk_fma_f32 v[210:211], v[178:179], s[54:55], v[234:235] op_sel_hi:[1,1,0] neg_lo:[1,0,0] neg_hi:[1,0,0]
    v_pk_fma_f32 v[226:227], v[194:195], s[54:55], v[238:239] op_sel_hi:[1,1,0] neg_lo:[1,0,0] neg_hi:[1,0,0]
    v_pk_fma_f32 v[178:179], v[178:179], s[54:55], v[232:233] op_sel_hi:[1,1,0]
    v_pk_fma_f32 v[194:195], v[194:195], s[54:55], v[236:237] op_sel_hi:[1,1,0]
    v_pk_fma_f32 v[212:213], v[180:181], s[54:55], v[234:235] op_sel_hi:[1,1,0] neg_lo:[1,0,0] neg_hi:[1,0,0]
    v_pk_fma_f32 v[228:229], v[196:197], s[54:55], v[238:239] op_sel_hi:[1,1,0] neg_lo:[1,0,0] neg_hi:[1,0,0]
    v_pk_fma_f32 v[180:181], v[180:181], s[54:55], v[232:233] op_sel_hi:[1,1,0]
    v_pk_fma_f32 v[196:197], v[196:197], s[54:55], v[236:237] op_sel_hi:[1,1,0]
    v_pk_fma_f32 v[214:215], v[182:183], s[54:55], v[234:235] op_sel_hi:[1,1,0] neg_lo:[1,0,0] neg_hi:[1,0,0]
    v_pk_fma_f32 v[230:231], v[198:199], s[54:55], v[238:239] op_sel_hi:[1,1,0] neg_lo:[1,0,0] neg_hi:[1,0,0]
    v_pk_fma_f32 v[182:183], v[182:183], s[54:55], v[232:233] op_sel_hi:[1,1,0]
    v_pk_fma_f32 v[198:199], v[198:199], s[54:55], v[236:237] op_sel_hi:[1,1,0]
    v_exp_f32 v200, v200
    v_exp_f32 v216, v216
    v_exp_f32 v168, v168
    v_exp_f32 v184, v184
    v_exp_f32 v201, v201
    v_exp_f32 v217, v217
    v_exp_f32 v169, v169
    v_exp_f32 v185, v185
    v_exp_f32 v202, v202
    v_exp_f32 v218, v218
    v_exp_f32 v170, v170
    v_exp_f32 v186, v186
    v_exp_f32 v203, v203
    v_exp_f32 v219, v219
    v_exp_f32 v171, v171
    v_exp_f32 v187, v187
    v_exp_f32 v204, v204
    v_exp_f32 v220, v220
    v_exp_f32 v172, v172
    v_exp_f32 v188, v188
    v_exp_f32 v205, v205
    v_exp_f32 v221, v221
    v_exp_f32 v173, v173
    v_exp_f32 v189, v189
    v_exp_f32 v206, v206
    v_exp_f32 v222, v222
    v_exp_f32 v174, v174
    v_exp_f32 v190, v190
    v_exp_f32 v207, v207
    v_exp_f32 v223, v223
    v_exp_f32 v175, v175
    v_exp_f32 v191, v191
    v_exp_f32 v208, v208
    v_exp_f32 v224, v224
    v_exp_f32 v176, v176
    v_exp_f32 v192, v192
    v_exp_f32 v209, v209
    v_exp_f32 v225, v225
    v_exp_f32 v177, v177
    v_exp_f32 v193, v193
    v_exp_f32 v210, v210
    v_exp_f32 v226, v226
    v_exp_f32 v178, v178
    v_exp_f32 v194, v194
    v_exp_f32 v211, v211
    v_exp_f32 v227, v227
    v_exp_f32 v179, v179
    v_exp_f32 v195, v195
    v_exp_f32 v212, v212
    v_exp_f32 v228, v228
    v_exp_f32 v180, v180
    v_exp_f32 v196, v196
    v_exp_f32 v213, v213
    v_exp_f32 v229, v229
    v_exp_f32 v181, v181
    v_exp_f32 v197, v197
    v_exp_f32 v214, v214
    v_exp_f32 v230, v230
    v_exp_f32 v182, v182
    v_exp_f32 v198, v198
    v_exp_f32 v215, v215
    v_exp_f32 v231, v231
    v_exp_f32 v183, v183
    v_exp_f32 v199, v199
    v_pk_add_f32 v[234:235], v[200:201], v[202:203]
    v_pk_add_f32 v[238:239], v[216:217], v[218:219]
    v_pk_add_f32 v[232:233], v[168:169], v[170:171]
    v_pk_add_f32 v[236:237], v[184:185], v[186:187]
    v_pk_add_f32 v[234:235], v[234:235], v[204:205]
    v_pk_add_f32 v[238:239], v[238:239], v[220:221]
    v_pk_add_f32 v[232:233], v[232:233], v[172:173]
    v_pk_add_f32 v[236:237], v[236:237], v[188:189]
    v_pk_add_f32 v[234:235], v[234:235], v[206:207]
    v_pk_add_f32 v[238:239], v[238:239], v[222:223]
    v_pk_add_f32 v[232:233], v[232:233], v[174:175]
    v_pk_add_f32 v[236:237], v[236:237], v[190:191]
    v_pk_add_f32 v[234:235], v[234:235], v[208:209]
    v_pk_add_f32 v[238:239], v[238:239], v[224:225]
    v_pk_add_f32 v[232:233], v[232:233], v[176:177]
    v_pk_add_f32 v[236:237], v[236:237], v[192:193]
    v_pk_add_f32 v[234:235], v[234:235], v[210:211]
    v_pk_add_f32 v[238:239], v[238:239], v[226:227]
    v_pk_add_f32 v[232:233], v[232:233], v[178:179]
    v_pk_add_f32 v[236:237], v[236:237], v[194:195]
    v_pk_add_f32 v[234:235], v[234:235], v[212:213]
    v_pk_add_f32 v[238:239], v[238:239], v[228:229]
    v_pk_add_f32 v[232:233], v[232:233], v[180:181]
    v_pk_add_f32 v[236:237], v[236:237], v[196:197]
    v_pk_add_f32 v[234:235], v[234:235], v[214:215]
    v_pk_add_f32 v[238:239], v[238:239], v[230:231]
    v_pk_add_f32 v[232:233], v[232:233], v[182:183]
    v_pk_add_f32 v[236:237], v[236:237], v[198:199]
    v_add_f32 v234, v234, v235
    v_add_f32 v238, v238, v239
    v_add_f32 v232, v232, v233
    v_add_f32 v236, v236, v237
    s_nop 0
    v_permlane32_swap_b32 v232, v234
    v_permlane32_swap_b32 v236, v238
    v_add_f32 v232, v232, v234
    v_add_f32 v236, v236, v238
    v_rcp_f32 v232, v232
    v_rcp_f32 v236, v236
    v_mov_b32 v234, v232
    v_mov_b32 v238, v236
    s_nop 0
    v_permlane32_swap_b32 v232, v234
    v_permlane32_swap_b32 v236, v238
    v_pk_mul_f32 v[200:201], v[200:201], v[234:235] op_sel_hi:[1,0]
    v_pk_mul_f32 v[216:217], v[216:217], v[238:239] op_sel_hi:[1,0]
    v_pk_mul_f32 v[202:203], v[202:203], v[234:235] op_sel_hi:[1,0]
    v_pk_mul_f32 v[218:219], v[218:219], v[238:239] op_sel_hi:[1,0]
    v_pk_mul_f32 v[204:205], v[204:205], v[234:235] op_sel_hi:[1,0]
    v_pk_mul_f32 v[220:221], v[220:221], v[238:239] op_sel_hi:[1,0]
    v_pk_mul_f32 v[206:207], v[206:207], v[234:235] op_sel_hi:[1,0]
    v_pk_mul_f32 v[222:223], v[222:223], v[238:239] op_sel_hi:[1,0]
    v_pk_mul_f32 v[208:209], v[208:209], v[234:235] op_sel_hi:[1,0]
    v_pk_mul_f32 v[224:225], v[224:225], v[238:239] op_sel_hi:[1,0]
    v_pk_mul_f32 v[210:211], v[210:211], v[234:235] op_sel_hi:[1,0]
    v_pk_mul_f32 v[226:227], v[226:227], v[238:239] op_sel_hi:[1,0]
    v_pk_mul_f32 v[212:213], v[212:213], v[234:235] op_sel_hi:[1,0]
    v_pk_mul_f32 v[228:229], v[228:229], v[238:239] op_sel_hi:[1,0]
    v_pk_mul_f32 v[214:215], v[214:215], v[234:235] op_sel_hi:[1,0]
    v_pk_mul_f32 v[230:231], v[230:231], v[238:239] op_sel_hi:[1,0]
    v_cvt_pk_bf16_f32 v24, v200, v201
    v_cvt_pk_bf16_f32 v40, v216, v217
    v_cvt_pk_bf16_f32 v25, v202, v203
    v_cvt_pk_bf16_f32 v41, v218, v219
    v_cvt_pk_bf16_f32 v26, v204, v205
    v_cvt_pk_bf16_f32 v42, v220, v221
    v_cvt_pk_bf16_f32 v27, v206, v207
    v_cvt_pk_bf16_f32 v43, v222, v223
    v_cvt_pk_bf16_f32 v28, v208, v209
    v_cvt_pk_bf16_f32 v44, v224, v225
    v_cvt_pk_bf16_f32 v29, v210, v211
    v_cvt_pk_bf16_f32 v45, v226, v227
    v_cvt_pk_bf16_f32 v30, v212, v213
    v_cvt_pk_bf16_f32 v46, v228, v229
    v_cvt_pk_bf16_f32 v31, v214, v215
    v_cvt_pk_bf16_f32 v47, v230, v231
    v_pk_mul_f32 v[168:169], v[168:169], v[232:233] op_sel_hi:[1,0]
    v_pk_mul_f32 v[184:185], v[184:185], v[236:237] op_sel_hi:[1,0]
    v_pk_mul_f32 v[170:171], v[170:171], v[232:233] op_sel_hi:[1,0]
    v_pk_mul_f32 v[186:187], v[186:187], v[236:237] op_sel_hi:[1,0]
    v_pk_mul_f32 v[172:173], v[172:173], v[232:233] op_sel_hi:[1,0]
    v_pk_mul_f32 v[188:189], v[188:189], v[236:237] op_sel_hi:[1,0]
    v_pk_mul_f32 v[174:175], v[174:175], v[232:233] op_sel_hi:[1,0]
    v_pk_mul_f32 v[190:191], v[190:191], v[236:237] op_sel_hi:[1,0]
    v_pk_mul_f32 v[176:177], v[176:177], v[232:233] op_sel_hi:[1,0]
    v_pk_mul_f32 v[192:193], v[192:193], v[236:237] op_sel_hi:[1,0]
    v_pk_mul_f32 v[178:179], v[178:179], v[232:233] op_sel_hi:[1,0]
    v_pk_mul_f32 v[194:195], v[194:195], v[236:237] op_sel_hi:[1,0]
    v_pk_mul_f32 v[180:181], v[180:181], v[232:233] op_sel_hi:[1,0]
    v_pk_mul_f32 v[196:197], v[196:197], v[236:237] op_sel_hi:[1,0]
    v_pk_mul_f32 v[182:183], v[182:183], v[232:233] op_sel_hi:[1,0]
    v_pk_mul_f32 v[198:199], v[198:199], v[236:237] op_sel_hi:[1,0]
    v_cvt_pk_bf16_f32 v16, v168, v169
    v_cvt_pk_bf16_f32 v32, v184, v185
    v_cvt_pk_bf16_f32 v17, v170, v171
    v_cvt_pk_bf16_f32 v33, v186, v187
    v_cvt_pk_bf16_f32 v18, v172, v173
    v_cvt_pk_bf16_f32 v34, v188, v189
    v_cvt_pk_bf16_f32 v19, v174, v175
    v_cvt_pk_bf16_f32 v35, v190, v191
    v_cvt_pk_bf16_f32 v20, v176, v177
    v_cvt_pk_bf16_f32 v36, v192, v193
    v_cvt_pk_bf16_f32 v21, v178, v179
    v_cvt_pk_bf16_f32 v37, v194, v195
    v_cvt_pk_bf16_f32 v22, v180, v181
    v_cvt_pk_bf16_f32 v38, v196, v197
    v_cvt_pk_bf16_f32 v23, v182, v183
    v_cvt_pk_bf16_f32 v39, v198, v199
    v_and_b32 v2, 15, v0
    v_lshlrev_b32 v2, 7, v2
    v_mov_b32 v1, 77736
    v_mov_b32 v7, 1
    s_mov_b64 exec, 1
    ds_add_u32 v1, v7
    s_mov_b64 exec, -1
    v_and_b32 v8, 31, v0
    v_lshrrev_b32 v9, 4, v8
    v_lshlrev_b32 v9, 5, v9
    v_bfe_u32 v10, v8, 2, 1
    v_lshl_add_u32 v9, v10, 4, v9
    v_bfe_u32 v10, v8, 3, 1
    v_lshl_add_u32 v9, v10, 3, v9
    v_and_b32 v10, 3, v8
    v_lshl_add_u32 v9, v10, 1, v9
    s_lshl_b32 s70, s42, 7
    s_add_u32 s70, s70, 86016
    s_lshl_b32 s71, s43, 6
    s_add_u32 s71, s71, s70
    v_add_u32 v9, s71, v9
    v_lshrrev_b32 v11, 5, v0
    v_lshl_add_u32 v10, v11, 4, s71
    v_xor_b32 v11, 64, v10
    s_lshl_b32 s71, s40, 11
    s_add_u32 s71, s71, 77824
    v_add_u32 v12, s71, v5
    s_xor_b32 s71, s40, 2
    s_lshl_b32 s71, s71, 11
    s_add_u32 s71, s71, 77824
    v_add_u32 v13, s71, v5
    s_lshl_b32 s74, s73, 11
    s_add_u32 s74, s74, 12582912
    v_mov_b32 v1, 77768
    v_mov_b32 v7, 1
    s_mov_b64 exec, 1
    ds_add_rtn_u32 v7, v1, v7
    s_mov_b64 exec, -1
    s_waitcnt lgkmcnt(0)
    v_readfirstlane_b32 s78, v7
    s_nop 1
    s_cmp_lg_u32 s78, 3
    s_cbranch_scc1 k_poll_w
    s_mov_b32 s79, 1048576
    s_branch k_poll
k_poll_again:
    s_sleep 4
k_poll:
    buffer_load_dword v4, v2, s[56:59], s76 offen sc1
    s_sub_u32 s79, s79, 1
    s_cbranch_scc1 k_poll_x
    s_waitcnt vmcnt(0)
    v_cmp_ne_u32 vcc, s53, v4
    s_cbranch_vccnz k_poll_again
k_poll_x:
    s_waitcnt vmcnt(0)
    v_mov_b32 v1, 77768
    v_mov_b32 v7, 1
    s_mov_b64 exec, 1
    ds_add_u32 v1, v7
    s_mov_b64 exec, -1
k_poll_w:
    v_mov_b32 v1, 77768
    s_mov_b32 s79, 1048576
k_poll_l:
    ds_read_b32 v7, v1
    s_sub_u32 s79, s79, 1
    s_cbranch_scc1 k_poll_l_x
    s_waitcnt lgkmcnt(0)
    v_readfirstlane_b32 s78, v7
    s_nop 1
    s_cmp_ge_u32 s78, 5
    s_cbranch_scc1 k_poll_l_x
    s_branch k_poll_l
k_poll_l_x:
    s_waitcnt lgkmcnt(0)
    s_waitcnt vmcnt(0)
    buffer_load_dword v48, v6, s[56:59], s75 offen offset:0 sc1
    buffer_load_dword v49, v6, s[56:59], s75 offen offset:256 sc1
    buffer_load_dword v50, v6, s[56:59], s75 offen offset:512 sc1
    buffer_load_dword v51, v6, s[56:59], s75 offen offset:768 sc1
    buffer_load_dword v52, v6, s[56:59], s75 offen offset:1024 sc1
    buffer_load_dword v53, v6, s[56:59], s75 offen offset:1280 sc1
    buffer_load_dword v54, v6, s[56:59], s75 offen offset:1536 sc1
    buffer_load_dword v55, v6, s[56:59], s75 offen offset:1792 sc1
    s_add_u32 s60, s39, 0
    s_and_b32 s60, s60, 7
    s_lshl_b32 s60, s60, 12
    s_add_u32 s60, s60, s74
    buffer_load_dwordx4 v[112:115], v5, s[56:59], s60 offen offset:0 sc1
    buffer_load_dwordx4 v[116:119], v5, s[56:59], s60 offen offset:1024 sc1
    buffer_load_dwordx4 v[120:123], v5, s[56:59], s60 offen offset:2048 sc1
    buffer_load_dwordx4 v[124:127], v5, s[56:59], s60 offen offset:3072 sc1
    s_add_u32 s60, s39, 1
    s_and_b32 s60, s60, 7
    s_lshl_b32 s60, s60, 12
    s_add_u32 s60, s60, s74
    buffer_load_dwordx4 v[128:131], v5, s[56:59], s60 offen offset:0 sc1
    buffer_load_dwordx4 v[132:135], v5, s[56:59], s60 offen offset:1024 sc1
    buffer_load_dwordx4 v[136:139], v5, s[56:59], s60 offen offset:2048 sc1
    buffer_load_dwordx4 v[140:143], v5, s[56:59], s60 offen offset:3072 sc1
    s_add_u32 s60, s39, 2
    s_and_b32 s60, s60, 7
    s_lshl_b32 s60, s60, 12
    s_add_u32 s60, s60, s74
    buffer_load_dwordx4 v[144:147], v5, s[56:59], s60 offen offset:0 sc1
    buffer_load_dwordx4 v[148:151], v5, s[56:59], s60 offen offset:1024 sc1
    buffer_load_dwordx4 v[152:155], v5, s[56:59], s60 offen offset:2048 sc1
    buffer_load_dwordx4 v[156:159], v5, s[56:59], s60 offen offset:3072 sc1
    s_add_u32 s60, s39, 3
    s_and_b32 s60, s60, 7
    s_lshl_b32 s60, s60, 12
    s_add_u32 s60, s60, s74
    buffer_load_dwordx4 v[160:163], v5, s[56:59], s60 offen offset:0 sc1
    buffer_load_dwordx4 v[164:167], v5, s[56:59], s60 offen offset:1024 sc1
    buffer_load_dwordx4 v[168:171], v5, s[56:59], s60 offen offset:2048 sc1
    buffer_load_dwordx4 v[172:175], v5, s[56:59], s60 offen offset:3072 sc1
    s_add_u32 s60, s39, 4
    s_and_b32 s60, s60, 7
    s_lshl_b32 s60, s60, 12
    s_add_u32 s60, s60, s74
    buffer_load_dwordx4 v[176:179], v5, s[56:59], s60 offen offset:0 sc1
    buffer_load_dwordx4 v[180:183], v5, s[56:59], s60 offen offset:1024 sc1
    buffer_load_dwordx4 v[184:187], v5, s[56:59], s60 offen offset:2048 sc1
    buffer_load_dwordx4 v[188:191], v5, s[56:59], s60 offen offset:3072 sc1
    s_add_u32 s60, s39, 5
    s_and_b32 s60, s60, 7
    s_lshl_b32 s60, s60, 12
    s_add_u32 s60, s60, s74
    buffer_load_dwordx4 v[192:195], v5, s[56:59], s60 offen offset:0 sc1
    buffer_load_dwordx4 v[196:199], v5, s[56:59], s60 offen offset:1024 sc1
    buffer_load_dwordx4 v[200:203], v5, s[56:59], s60 offen offset:2048 sc1
    buffer_load_dwordx4 v[204:207], v5, s[56:59], s60 offen offset:3072 sc1
    s_add_u32 s60, s39, 6
    s_and_b32 s60, s60, 7
    s_lshl_b32 s60, s60, 12
    s_add_u32 s60, s60, s74
    buffer_load_dwordx4 v[208:211], v5, s[56:59], s60 offen offset:0 sc1
    buffer_load_dwordx4 v[212:215], v5, s[56:59], s60 offen offset:1024 sc1
    buffer_load_dwordx4 v[216:219], v5, s[56:59], s60 offen offset:2048 sc1
    buffer_load_dwordx4 v[220:223], v5, s[56:59], s60 offen offset:3072 sc1
    s_add_u32 s60, s39, 7
    s_and_b32 s60, s60, 7
    s_lshl_b32 s60, s60, 12
    s_add_u32 s60, s60, s74
    buffer_load_dwordx4 v[224:227], v5, s[56:59], s60 offen offset:0 sc1
    buffer_load_dwordx4 v[228:231], v5, s[56:59], s60 offen offset:1024 sc1
    buffer_load_dwordx4 v[232:235], v5, s[56:59], s60 offen offset:2048 sc1
    buffer_load_dwordx4 v[236:239], v5, s[56:59], s60 offen offset:3072 sc1
    s_waitcnt vmcnt(32)
    v_add_f32 v48, v48, v49
    v_add_f32 v50, v50, v51
    v_add_f32 v52, v52, v53
    v_add_f32 v54, v54, v55
    v_add_f32 v48, v48, v50
    v_add_f32 v52, v52, v54
    v_add_f32 v48, v48, v52
    v_mov_b32 v49, v48
    s_nop 1
    v_permlane32_swap_b32 v48, v49
    v_add_f32 v48, v48, v49
    v_cvt_pk_bf16_f32 v48, v48, v48
    ds_write_b16 v9, v48
    s_waitcnt vmcnt(31)
    v_mfma_f32_32x32x16_bf16 v[80:95], v[64:67], v[112:115], 0
    s_waitcnt vmcnt(30)
    v_mfma_f32_32x32x16_bf16 v[80:95], v[68:71], v[116:119], v[80:95]
    s_waitcnt vmcnt(29)
    v_mfma_f32_32x32x16_bf16 v[80:95], v[64:67], v[120:123], v[80:95]
    s_waitcnt vmcnt(28)
    v_mfma_f32_32x32x16_bf16 v[80:95], v[68:71], v[124:127], v[80:95]
    s_waitcnt vmcnt(27)
    v_mfma_f32_32x32x16_bf16 v[80:95], v[64:67], v[128:131], v[80:95]
    s_waitcnt vmcnt(26)
    v_mfma_f32_32x32x16_bf16 v[80:95], v[68:71], v[132:135], v[80:95]
    s_waitcnt vmcnt(25)
    v_mfma_f32_32x32x16_bf16 v[80:95], v[64:67], v[136:139], v[80:95]
    s_waitcnt vmcnt(24)
    v_mfma_f32_32x32x16_bf16 v[80:95], v[68:71], v[140:143], v[80:95]
    s_waitcnt vmcnt(23)
    v_mfma_f32_32x32x16_bf16 v[80:95], v[64:67], v[144:147], v[80:95]
    s_waitcnt vmcnt(22)
    v_mfma_f32_32x32x16_bf16 v[80:95], v[68:71], v[148:151], v[80:95]
    s_waitcnt vmcnt(21)
    v_mfma_f32_32x32x16_bf16 v[80:95], v[64:67], v[152:155], v[80:95]
    s_waitcnt vmcnt(20)
    v_mfma_f32_32x32x16_bf16 v[80:95], v[68:71], v[156:159], v[80:95]
    s_waitcnt vmcnt(19)
    v_mfma_f32_32x32x16_bf16 v[80:95], v[64:67], v[160:163], v[80:95]
    s_waitcnt vmcnt(18)
    v_mfma_f32_32x32x16_bf16 v[80:95], v[68:71], v[164:167], v[80:95]
    s_waitcnt vmcnt(17)
    v_mfma_f32_32x32x16_bf16 v[80:95], v[64:67], v[168:171], v[80:95]
    s_waitcnt vmcnt(16)
    v_mfma_f32_32x32x16_bf16 v[80:95], v[68:71], v[172:175], v[80:95]
    s_waitcnt vmcnt(15)
    v_mfma_f32_32x32x16_bf16 v[80:95], v[64:67], v[176:179], v[80:95]
    s_waitcnt vmcnt(14)
    v_mfma_f32_32x32x16_bf16 v[80:95], v[68:71], v[180:183], v[80:95]
    s_waitcnt vmcnt(13)
    v_mfma_f32_32x32x16_bf16 v[80:95], v[64:67], v[184:187], v[80:95]
    s_waitcnt vmcnt(12)
    v_mfma_f32_32x32x16_bf16 v[80:95], v[68:71], v[188:191], v[80:95]
    s_waitcnt vmcnt(11)
    v_mfma_f32_32x32x16_bf16 v[80:95], v[64:67], v[192:195], v[80:95]
    s_waitcnt vmcnt(10)
    v_mfma_f32_32x32x16_bf16 v[80:95], v[68:71], v[196:199], v[80:95]
    s_waitcnt vmcnt(9)
    v_mfma_f32_32x32x16_bf16 v[80:95], v[64:67], v[200:203], v[80:95]
    s_waitcnt vmcnt(8)
    v_mfma_f32_32x32x16_bf16 v[80:95], v[68:71], v[204:207], v[80:95]
    s_waitcnt vmcnt(7)
    v_mfma_f32_32x32x16_bf16 v[80:95], v[64:67], v[208:211], v[80:95]
    s_waitcnt vmcnt(6)
    v_mfma_f32_32x32x16_bf16 v[80:95], v[68:71], v[212:215], v[80:95]
    s_waitcnt vmcnt(5)
    v_mfma_f32_32x32x16_bf16 v[80:95], v[64:67], v[216:219], v[80:95]
    s_waitcnt vmcnt(4)
    v_mfma_f32_32x32x16_bf16 v[80:95], v[68:71], v[220:223], v[80:95]
    s_waitcnt vmcnt(3)
    v_mfma_f32_32x32x16_bf16 v[80:95], v[64:67], v[224:227], v[80:95]
    s_waitcnt vmcnt(2)
    v_mfma_f32_32x32x16_bf16 v[80:95], v[68:71], v[228:231], v[80:95]
    s_waitcnt vmcnt(1)
    v_mfma_f32_32x32x16_bf16 v[80:95], v[64:67], v[232:235], v[80:95]
    s_waitcnt vmcnt(0)
    v_mfma_f32_32x32x16_bf16 v[80:95], v[68:71], v[236:239], v[80:95]
    v_mov_b32 v1, 77756
    v_mov_b32 v7, 1
    s_mov_b64 exec, 1
    ds_add_u32 v1, v7
    s_mov_b64 exec, -1
    s_lshl_b32 s70, s39, 1
    s_add_u32 s70, s70, s43
    s_lshl_b32 s70, s70, 17
    s_lshl_b32 s71, s44, 11
    s_add_u32 s70, s70, s71
    s_add_u32 s70, s70, 8388608
    s_add_u32 s71, s70, 65536
    v_cvt_pk_bf16_f32 v96, v80, v81
    v_cvt_pk_bf16_f32 v97, v82, v83
    v_cvt_pk_bf16_f32 v98, v84, v85
    v_cvt_pk_bf16_f32 v99, v86, v87
    v_cvt_pk_bf16_f32 v100, v88, v89
    v_cvt_pk_bf16_f32 v101, v90, v91
    v_cvt_pk_bf16_f32 v102, v92, v93
    v_cvt_pk_bf16_f32 v103, v94, v95
    ds_write_b128 v12, v[96:99] offset:0
    ds_write_b128 v12, v[100:103] offset:1024
    v_mfma_f32_32x32x16_bf16 v[144:159], v[96:99], v[16:19], 0
    v_mfma_f32_32x32x16_bf16 v[160:175], v[96:99], v[32:35], 0
    v_mfma_f32_32x32x16_bf16 v[144:159], v[100:103], v[20:23], v[144:159]
    v_mfma_f32_32x32x16_bf16 v[160:175], v[100:103], v[36:39], v[160:175]
    s_waitcnt lgkmcnt(0)
    v_mov_b32 v1, s62
    v_mov_b32 v7, 1
    s_mov_b64 exec, 1
    ds_add_u32 v1, v7
    s_mov_b64 exec, -1
    v_mov_b32 v1, s62
    s_mov_b32 s79, 1048576
k_spinC:
    ds_read_b32 v7, v1
    s_sub_u32 s79, s79, 1
    s_cbranch_scc1 k_spinC_x
    s_waitcnt lgkmcnt(0)
    v_readfirstlane_b32 s78, v7
    s_nop 1
    s_cmp_ge_u32 s78, 4
    s_cbranch_scc1 k_spinC_x
    s_branch k_spinC
k_spinC_x:
    s_waitcnt lgkmcnt(0)
    s_nop 0
    ds_read_b128 v[112:115], v10 offset:0
    ds_read_b128 v[116:119], v10 offset:32
    ds_read_b128 v[120:123], v11 offset:0
    ds_read_b128 v[124:127], v11 offset:32
    ds_read_b128 v[104:107], v13 offset:0
    ds_read_b128 v[108:111], v13 offset:1024
    s_waitcnt lgkmcnt(5)
    v_mfma_f32_32x32x16_bf16 v[176:191], v[112:115], v[16:19], 0
    v_mfma_f32_32x32x16_bf16 v[192:207], v[112:115], v[32:35], 0
    s_waitcnt lgkmcnt(4)
    v_mfma_f32_32x32x16_bf16 v[176:191], v[116:119], v[20:23], v[176:191]
    v_mfma_f32_32x32x16_bf16 v[192:207], v[116:119], v[36:39], v[192:207]
    s_waitcnt lgkmcnt(3)
    v_mfma_f32_32x32x16_bf16 v[176:191], v[120:123], v[24:27], v[176:191]
    v_mfma_f32_32x32x16_bf16 v[192:207], v[120:123], v[40:43], v[192:207]
    s_waitcnt lgkmcnt(2)
    v_mfma_f32_32x32x16_bf16 v[176:191], v[124:127], v[28:31], v[176:191]
    v_mfma_f32_32x32x16_bf16 v[192:207], v[124:127], v[44:47], v[192:207]
    s_waitcnt lgkmcnt(1)
    v_mfma_f32_32x32x16_bf16 v[144:159], v[104:107], v[24:27], v[144:159]
    s_waitcnt lgkmcnt(0)
    v_mfma_f32_32x32x16_bf16 v[144:159], v[108:111], v[28:31], v[144:159]
    v_mfma_f32_32x32x16_bf16 v[160:175], v[104:107], v[40:43], v[160:175]
    v_mfma_f32_32x32x16_bf16 v[160:175], v[108:111], v[44:47], v[160:175]
    s_nop 4
    v_add_f32 v176, 0x358637bd, v176
    v_rcp_f32 v176, v176
    v_add_f32 v192, 0x358637bd, v192
    v_rcp_f32 v192, v192
    s_lshl_b32 s75, s39, 4
    s_add_u32 s75, s75, s38
    s_lshl_b32 s75, s75, 7
    s_add_u32 s75, s75, 14974976
    s_lshl_b32 s76, s100, 11
    s_add_u32 s76, s76, 14974976
    v_lshrrev_b32 v8, 5, v0
    v_bfe_u32 v9, v0, 2, 2
    v_lshl_add_u32 v10, v8, 2, v9
    v_lshlrev_b32 v10, 7, v10
    v_mul_f32 v144, v144, v176
    v_mul_f32 v145, v145, v176
    v_mul_f32 v146, v146, v176
    v_mul_f32 v147, v147, v176
    v_mul_f32 v148, v148, v176
    v_mul_f32 v149, v149, v176
    v_mul_f32 v150, v150, v176
    v_mul_f32 v151, v151, v176
    v_mul_f32 v152, v152, v176
    v_mul_f32 v153, v153, v176
    v_mul_f32 v154, v154, v176
    v_mul_f32 v155, v155, v176
    v_mul_f32 v156, v156, v176
    v_mul_f32 v157, v157, v176
    v_mul_f32 v158, v158, v176
    v_mul_f32_e64 v159, v159, v176
    v_cvt_pk_bf16_f32 v208, v144, v145
    v_cvt_pk_bf16_f32 v209, v146, v147
    v_cvt_pk_bf16_f32 v210, v148, v149
    v_cvt_pk_bf16_f32 v211, v150, v151
    v_cvt_pk_bf16_f32 v212, v152, v153
    v_cvt_pk_bf16_f32 v213, v154, v155
    v_cvt_pk_bf16_f32 v214, v156, v157
    v_cvt_pk_bf16_f32 v215, v158, v159
    buffer_store_dwordx4 v[208:211], v5, s[56:59], s70 offen offset:0 sc1
    buffer_store_dwordx4 v[212:215], v5, s[56:59], s70 offen offset:1024 sc1
    v_mul_f32 v160, v160, v192
    v_mul_f32 v161, v161, v192
    v_mul_f32 v162, v162, v192
    v_mul_f32 v163, v163, v192
    v_mul_f32 v164, v164, v192
    v_mul_f32 v165, v165, v192
    v_mul_f32 v166, v166, v192
    v_mul_f32 v167, v167, v192
    v_mul_f32 v168, v168, v192
    v_mul_f32 v169, v169, v192
    v_mul_f32 v170, v170, v192
    v_mul_f32 v171, v171, v192
    v_mul_f32 v172, v172, v192
    v_mul_f32 v173, v173, v192
    v_mul_f32 v174, v174, v192
    v_mul_f32 v175, v175, v192
    v_cvt_pk_bf16_f32 v216, v160, v161
    v_cvt_pk_bf16_f32 v217, v162, v163
    v_cvt_pk_bf16_f32 v218, v164, v165
    v_cvt_pk_bf16_f32 v219, v166, v167
    v_cvt_pk_bf16_f32 v220, v168, v169
    v_cvt_pk_bf16_f32 v221, v170, v171
    v_cvt_pk_bf16_f32 v222, v172, v173
    v_cvt_pk_bf16_f32 v223, v174, v175
    buffer_store_dwordx4 v[216:219], v5, s[56:59], s71 offen offset:0 sc1
    buffer_store_dwordx4 v[220:223], v5, s[56:59], s71 offen offset:1024 sc1
    v_and_b32_e64 v11, 1, v0
    v_lshl_add_u32 v10, v11, 5, v10
    v_bfe_u32 v11, v0, 4, 1
    v_lshl_add_u32 v10, v11, 4, v10
    v_bfe_u32 v11, v0, 1, 1
    v_lshl_add_u32 v10, v11, 3, v10
    v_lshrrev_b32 v9, 1, v9
    v_lshl_add_u32 v10, v9, 6, v10
    v_xor_b32 v11, 64, v10
    v_add_u32 v12, 65536, v10
    v_add_u32 v13, 65536, v11
    v_add_u32 v14, 131072, v10
    v_add_u32 v15, 131072, v11
    v_and_b32 v4, 15, v0
    v_lshlrev_b32 v4, 7, v4
    s_lshl_b32 s77, s100, 2
    s_add_u32 s77, s77, s40
    s_lshl_b32 s77, s77, 16
    s_add_u32 s77, s77, 8388608
    s_waitcnt vmcnt(0)
    v_mov_b32 v1, 77772
    v_mov_b32 v7, 1
    s_mov_b64 exec, 1
    ds_add_rtn_u32 v7, v1, v7
    s_mov_b64 exec, -1
    s_waitcnt lgkmcnt(0)
    v_readfirstlane_b32 s78, v7
    s_nop 1
    s_cmp_lg_u32 s78, 3
    s_cbranch_scc1 k_osig
    v_mov_b32 v72, s53
    v_mov_b32 v73, s53
    v_mov_b32 v74, s53
    v_mov_b32 v75, s53
    s_mov_b64 exec, 0xff
    buffer_store_dwordx4 v[72:75], v5, s[56:59], s75 offen sc1
    s_mov_b64 exec, -1
k_osig:
    v_mov_b32 v1, 77744
    s_mov_b32 s79, 1048576
k_wo1:
    ds_read_b32 v7, v1
    s_sub_u32 s79, s79, 1
    s_cbranch_scc1 k_wo1_x
    s_waitcnt lgkmcnt(0)
    v_readfirstlane_b32 s78, v7
    s_nop 1
    s_cmp_ge_u32 s78, 4
    s_cbranch_scc1 k_wo1_x
    s_branch k_wo1
k_wo1_x:
    s_waitcnt lgkmcnt(0)
    v_mov_b32 v1, 77776
    v_mov_b32 v7, 1
    s_mov_b64 exec, 1
    ds_add_rtn_u32 v7, v1, v7
    s_mov_b64 exec, -1
    s_waitcnt lgkmcnt(0)
    v_readfirstlane_b32 s78, v7
    s_nop 1
    s_cmp_lg_u32 s78, 3
    s_cbranch_scc1 k_opoll_w
    s_mov_b32 s79, 1048576
    s_branch k_opoll
k_opoll_again:
    s_sleep 4
k_opoll:
    buffer_load_dword v9, v4, s[56:59], s76 offen sc1
    s_sub_u32 s79, s79, 1
    s_cbranch_scc1 k_opoll_x
    s_waitcnt vmcnt(0)
    v_cmp_ne_u32 vcc, s53, v9
    s_cbranch_vccnz k_opoll_again
k_opoll_x:
    s_waitcnt vmcnt(0)
    v_mov_b32 v1, 77776
    v_mov_b32 v7, 1
    s_mov_b64 exec, 1
    ds_add_u32 v1, v7
    s_mov_b64 exec, -1
k_opoll_w:
    v_mov_b32 v1, 77776
    s_mov_b32 s79, 1048576
k_opoll_l:
    ds_read_b32 v7, v1
    s_sub_u32 s79, s79, 1
    s_cbranch_scc1 k_opoll_l_x
    s_waitcnt lgkmcnt(0)
    v_readfirstlane_b32 s78, v7
    s_nop 1
    s_cmp_ge_u32 s78, 5
    s_cbranch_scc1 k_opoll_l_x
    s_branch k_opoll_l
k_opoll_l_x:
    s_waitcnt lgkmcnt(0)
    s_waitcnt vmcnt(0)
    s_or_b32 s60, s2, s40
    s_cmp_eq_u32 s60, 0
    s_cselect_b32 s60, 15466496, s72
    v_mov_b32 v2, 0
    v_mov_b32 v3, s53
    s_mov_b64 exec, 1
    buffer_store_dword v3, v2, s[56:59], s60 offen
    s_mov_b64 exec, -1
    s_add_u32 s60, s97, 0
    s_and_b32 s60, s60, 15
    s_lshl_b32 s60, s60, 12
    s_add_u32 s60, s60, s77
    buffer_load_dwordx4 v[72:75], v5, s[56:59], s60 offen offset:0 sc1
    buffer_load_dwordx4 v[76:79], v5, s[56:59], s60 offen offset:1024 sc1
    buffer_load_dwordx4 v[80:83], v5, s[56:59], s60 offen offset:2048 sc1
    buffer_load_dwordx4 v[84:87], v5, s[56:59], s60 offen offset:3072 sc1
    s_add_u32 s60, s97, 1
    s_and_b32 s60, s60, 15
    s_lshl_b32 s60, s60, 12
    s_add_u32 s60, s60, s77
    buffer_load_dwordx4 v[88:91], v5, s[56:59], s60 offen offset:0 sc1
    buffer_load_dwordx4 v[92:95], v5, s[56:59], s60 offen offset:1024 sc1
    buffer_load_dwordx4 v[96:99], v5, s[56:59], s60 offen offset:2048 sc1
    buffer_load_dwordx4 v[100:103], v5, s[56:59], s60 offen offset:3072 sc1
    s_add_u32 s60, s97, 2
    s_and_b32 s60, s60, 15
    s_lshl_b32 s60, s60, 12
    s_add_u32 s60, s60, s77
    buffer_load_dwordx4 v[104:107], v5, s[56:59], s60 offen offset:0 sc1
    buffer_load_dwordx4 v[108:111], v5, s[56:59], s60 offen offset:1024 sc1
    buffer_load_dwordx4 v[112:115], v5, s[56:59], s60 offen offset:2048 sc1
    buffer_load_dwordx4 v[116:119], v5, s[56:59], s60 offen offset:3072 sc1
    s_add_u32 s60, s97, 3
    s_and_b32 s60, s60, 15
    s_lshl_b32 s60, s60, 12
    s_add_u32 s60, s60, s77
    s_nop 0
    buffer_load_dwordx4 v[120:123], v5, s[56:59], s60 offen offset:0 sc1
    buffer_load_dwordx4 v[124:127], v5, s[56:59], s60 offen offset:1024 sc1
    buffer_load_dwordx4 v[128:131], v5, s[56:59], s60 offen offset:2048 sc1
    buffer_load_dwordx4 v[132:135], v5, s[56:59], s60 offen offset:3072 sc1
    ds_read_b64_tr_b16 v[48:49], v12 offset:57344
    ds_read_b64_tr_b16 v[50:51], v12 offset:58368
    ds_read_b64_tr_b16 v[52:53], v13 offset:57344
    ds_read_b64_tr_b16 v[54:55], v13 offset:58368
    ds_read_b64_tr_b16 v[56:57], v12 offset:59392
    ds_read_b64_tr_b16 v[58:59], v12 offset:60416
    ds_read_b64_tr_b16 v[60:61], v13 offset:59392
    ds_read_b64_tr_b16 v[62:63], v13 offset:60416
    ds_read_b64_tr_b16 v[64:65], v12 offset:61440
    ds_read_b64_tr_b16 v[66:67], v12 offset:62464
    ds_read_b64_tr_b16 v[68:69], v13 offset:61440
    ds_read_b64_tr_b16 v[70:71], v13 offset:62464
    s_waitcnt vmcnt(15)
    s_waitcnt lgkmcnt(10)
    v_mfma_f32_32x32x16_bf16 v[16:31], v[48:51], v[72:75], 0
    s_add_u32 s60, s97, 4
    s_and_b32 s60, s60, 15
    s_lshl_b32 s60, s60, 12
    s_add_u32 s60, s60, s77
    buffer_load_dwordx4 v[136:139], v5, s[56:59], s60 offen offset:0 sc1
    s_waitcnt lgkmcnt(8)
    s_nop 0
    v_mfma_f32_32x32x16_bf16 v[32:47], v[52:55], v[72:75], 0
    ds_read_b64_tr_b16 v[48:49], v12 offset:63488
    ds_read_b64_tr_b16 v[50:51], v12 offset:64512
    ds_read_b64_tr_b16 v[52:53], v13 offset:63488
    ds_read_b64_tr_b16 v[54:55], v13 offset:64512
    s_waitcnt vmcnt(15)
    s_waitcnt lgkmcnt(10)
    v_mfma_f32_32x32x16_bf16 v[16:31], v[56:59], v[76:79], v[16:31]
    buffer_load_dwordx4 v[140:143], v5, s[56:59], s60 offen offset:1024 sc1
    s_waitcnt lgkmcnt(8)
    s_nop 0
    v_mfma_f32_32x32x16_bf16 v[32:47], v[60:63], v[76:79], v[32:47]
    ds_read_b64_tr_b16 v[56:57], v14 offset:0
    ds_read_b64_tr_b16 v[58:59], v14 offset:1024
    ds_read_b64_tr_b16 v[60:61], v15 offset:0
    ds_read_b64_tr_b16 v[62:63], v15 offset:1024
    s_waitcnt vmcnt(15)
    s_waitcnt lgkmcnt(10)
    v_mfma_f32_32x32x16_bf16 v[16:31], v[64:67], v[80:83], v[16:31]
    buffer_load_dwordx4 v[72:75], v5, s[56:59], s60 offen offset:2048 sc1
    s_waitcnt lgkmcnt(8)
    s_nop 0
    v_mfma_f32_32x32x16_bf16 v[32:47], v[68:71], v[80:83], v[32:47]
    ds_read_b64_tr_b16 v[64:65], v14 offset:2048
    ds_read_b64_tr_b16 v[66:67], v14 offset:3072
    ds_read_b64_tr_b16 v[68:69], v15 offset:2048
    ds_read_b64_tr_b16 v[70:71], v15 offset:3072
    s_waitcnt vmcnt(15)
    s_waitcnt lgkmcnt(10)
    v_mfma_f32_32x32x16_bf16 v[16:31], v[48:51], v[84:87], v[16:31]
    buffer_load_dwordx4 v[76:79], v5, s[56:59], s60 offen offset:3072 sc1
    s_waitcnt lgkmcnt(8)
    s_nop 0
    v_mfma_f32_32x32x16_bf16 v[32:47], v[52:55], v[84:87], v[32:47]
    ds_read_b64_tr_b16 v[48:49], v14 offset:4096
    ds_read_b64_tr_b16 v[50:51], v14 offset:5120
    ds_read_b64_tr_b16 v[52:53], v15 offset:4096
    ds_read_b64_tr_b16 v[54:55], v15 offset:5120
    s_waitcnt vmcnt(15)
    s_waitcnt lgkmcnt(10)
    v_mfma_f32_32x32x16_bf16 v[16:31], v[56:59], v[88:91], v[16:31]
    s_add_u32 s60, s97, 5
    s_and_b32 s60, s60, 15
    s_lshl_b32 s60, s60, 12
    s_add_u32 s60, s60, s77
    buffer_load_dwordx4 v[80:83], v5, s[56:59], s60 offen offset:0 sc1
    s_waitcnt lgkmcnt(8)
    s_nop 0
    v_mfma_f32_32x32x16_bf16 v[32:47], v[60:63], v[88:91], v[32:47]
    ds_read_b64_tr_b16 v[56:57], v14 offset:6144
    ds_read_b64_tr_b16 v[58:59], v14 offset:7168
    ds_read_b64_tr_b16 v[60:61], v15 offset:6144
    ds_read_b64_tr_b16 v[62:63], v15 offset:7168
    s_waitcnt vmcnt(15)
    s_waitcnt lgkmcnt(10)
    v_mfma_f32_32x32x16_bf16 v[16:31], v[64:67], v[92:95], v[16:31]
    buffer_load_dwordx4 v[84:87], v5, s[56:59], s60 offen offset:1024 sc1
    s_waitcnt lgkmcnt(8)
    s_nop 0
    v_mfma_f32_32x32x16_bf16 v[32:47], v[68:71], v[92:95], v[32:47]
    ds_read_b64_tr_b16 v[64:65], v14 offset:8192
    ds_read_b64_tr_b16 v[66:67], v14 offset:9216
    ds_read_b64_tr_b16 v[68:69], v15 offset:8192
    ds_read_b64_tr_b16 v[70:71], v15 offset:9216
    s_waitcnt vmcnt(15)
    s_waitcnt lgkmcnt(10)
    v_mfma_f32_32x32x16_bf16 v[16:31], v[48:51], v[96:99], v[16:31]
    buffer_load_dwordx4 v[88:91], v5, s[56:59], s60 offen offset:2048 sc1
    s_waitcnt lgkmcnt(8)
    s_nop 0
    v_mfma_f32_32x32x16_bf16 v[32:47], v[52:55], v[96:99], v[32:47]
    ds_read_b64_tr_b16 v[48:49], v14 offset:10240
    ds_read_b64_tr_b16 v[50:51], v14 offset:11264
    ds_read_b64_tr_b16 v[52:53], v15 offset:10240
    ds_read_b64_tr_b16 v[54:55], v15 offset:11264
    s_waitcnt vmcnt(15)
    s_waitcnt lgkmcnt(10)
    v_mfma_f32_32x32x16_bf16 v[16:31], v[56:59], v[100:103], v[16:31]
    buffer_load_dwordx4 v[92:95], v5, s[56:59], s60 offen offset:3072 sc1
    s_waitcnt lgkmcnt(8)
    s_nop 0
    v_mfma_f32_32x32x16_bf16 v[32:47], v[60:63], v[100:103], v[32:47]
    ds_read_b64_tr_b16 v[56:57], v14 offset:12288
    ds_read_b64_tr_b16 v[58:59], v14 offset:13312
    ds_read_b64_tr_b16 v[60:61], v15 offset:12288
    ds_read_b64_tr_b16 v[62:63], v15 offset:13312
    s_waitcnt vmcnt(15)
    s_waitcnt lgkmcnt(10)
    v_mfma_f32_32x32x16_bf16 v[16:31], v[64:67], v[104:107], v[16:31]
    s_add_u32 s60, s97, 6
    s_and_b32 s60, s60, 15
    s_lshl_b32 s60, s60, 12
    s_add_u32 s60, s60, s77
    buffer_load_dwordx4 v[96:99], v5, s[56:59], s60 offen offset:0 sc1
    s_waitcnt lgkmcnt(8)
    s_nop 0
    v_mfma_f32_32x32x16_bf16 v[32:47], v[68:71], v[104:107], v[32:47]
    ds_read_b64_tr_b16 v[64:65], v14 offset:14336
    ds_read_b64_tr_b16 v[66:67], v14 offset:15360
    ds_read_b64_tr_b16 v[68:69], v15 offset:14336
    ds_read_b64_tr_b16 v[70:71], v15 offset:15360
    s_waitcnt vmcnt(15)
    s_waitcnt lgkmcnt(10)
    v_mfma_f32_32x32x16_bf16 v[16:31], v[48:51], v[108:111], v[16:31]
    buffer_load_dwordx4 v[100:103], v5, s[56:59], s60 offen offset:1024 sc1
    s_waitcnt lgkmcnt(8)
    s_nop 0
    v_mfma_f32_32x32x16_bf16 v[32:47], v[52:55], v[108:111], v[32:47]
    ds_read_b64_tr_b16 v[48:49], v14 offset:16384
    ds_read_b64_tr_b16 v[50:51], v14 offset:17408
    ds_read_b64_tr_b16 v[52:53], v15 offset:16384
    ds_read_b64_tr_b16 v[54:55], v15 offset:17408
    s_waitcnt vmcnt(15)
    s_waitcnt lgkmcnt(10)
    v_mfma_f32_32x32x16_bf16 v[16:31], v[56:59], v[112:115], v[16:31]
    buffer_load_dwordx4 v[104:107], v5, s[56:59], s60 offen offset:2048 sc1
    s_waitcnt lgkmcnt(8)
    s_nop 0
    v_mfma_f32_32x32x16_bf16 v[32:47], v[60:63], v[112:115], v[32:47]
    ds_read_b64_tr_b16 v[56:57], v14 offset:18432
    ds_read_b64_tr_b16 v[58:59], v14 offset:19456
    ds_read_b64_tr_b16 v[60:61], v15 offset:18432
    ds_read_b64_tr_b16 v[62:63], v15 offset:19456
    s_waitcnt vmcnt(15)
    s_waitcnt lgkmcnt(10)
    v_mfma_f32_32x32x16_bf16 v[16:31], v[64:67], v[116:119], v[16:31]
    buffer_load_dwordx4 v[108:111], v5, s[56:59], s60 offen offset:3072 sc1
    s_waitcnt lgkmcnt(8)
    s_nop 0
    v_mfma_f32_32x32x16_bf16 v[32:47], v[68:71], v[116:119], v[32:47]
    ds_read_b64_tr_b16 v[64:65], v14 offset:20480
    ds_read_b64_tr_b16 v[66:67], v14 offset:21504
    ds_read_b64_tr_b16 v[68:69], v15 offset:20480
    ds_read_b64_tr_b16 v[70:71], v15 offset:21504
    s_waitcnt vmcnt(15)
    s_waitcnt lgkmcnt(10)
    v_mfma_f32_32x32x16_bf16 v[16:31], v[48:51], v[120:123], v[16:31]
    s_add_u32 s60, s97, 7
    s_and_b32 s60, s60, 15
    s_lshl_b32 s60, s60, 12
    s_add_u32 s60, s60, s77
    buffer_load_dwordx4 v[112:115], v5, s[56:59], s60 offen offset:0 sc1
    s_waitcnt lgkmcnt(8)
    s_nop 0
    v_mfma_f32_32x32x16_bf16 v[32:47], v[52:55], v[120:123], v[32:47]
    ds_read_b64_tr_b16 v[48:49], v14 offset:22528
    ds_read_b64_tr_b16 v[50:51], v14 offset:23552
    ds_read_b64_tr_b16 v[52:53], v15 offset:22528
    ds_read_b64_tr_b16 v[54:55], v15 offset:23552
    s_waitcnt vmcnt(15)
    s_waitcnt lgkmcnt(10)
    v_mfma_f32_32x32x16_bf16 v[16:31], v[56:59], v[124:127], v[16:31]
    buffer_load_dwordx4 v[116:119], v5, s[56:59], s60 offen offset:1024 sc1
    s_waitcnt lgkmcnt(8)
    s_nop 0
    v_mfma_f32_32x32x16_bf16 v[32:47], v[60:63], v[124:127], v[32:47]
    ds_read_b64_tr_b16 v[56:57], v14 offset:24576
    ds_read_b64_tr_b16 v[58:59], v14 offset:25600
    ds_read_b64_tr_b16 v[60:61], v15 offset:24576
    ds_read_b64_tr_b16 v[62:63], v15 offset:25600
    s_waitcnt vmcnt(15)
    s_waitcnt lgkmcnt(10)
    v_mfma_f32_32x32x16_bf16 v[16:31], v[64:67], v[128:131], v[16:31]
    buffer_load_dwordx4 v[120:123], v5, s[56:59], s60 offen offset:2048 sc1
    s_waitcnt lgkmcnt(8)
    s_nop 0
    v_mfma_f32_32x32x16_bf16 v[32:47], v[68:71], v[128:131], v[32:47]
    ds_read_b64_tr_b16 v[64:65], v14 offset:26624
    ds_read_b64_tr_b16 v[66:67], v14 offset:27648
    ds_read_b64_tr_b16 v[68:69], v15 offset:26624
    ds_read_b64_tr_b16 v[70:71], v15 offset:27648
    s_waitcnt vmcnt(15)
    s_waitcnt lgkmcnt(10)
    v_mfma_f32_32x32x16_bf16 v[16:31], v[48:51], v[132:135], v[16:31]
    buffer_load_dwordx4 v[124:127], v5, s[56:59], s60 offen offset:3072 sc1
    s_waitcnt lgkmcnt(8)
    s_nop 0
    v_mfma_f32_32x32x16_bf16 v[32:47], v[52:55], v[132:135], v[32:47]
    ds_read_b64_tr_b16 v[48:49], v14 offset:28672
    ds_read_b64_tr_b16 v[50:51], v14 offset:29696
    ds_read_b64_tr_b16 v[52:53], v15 offset:28672
    ds_read_b64_tr_b16 v[54:55], v15 offset:29696
    s_waitcnt vmcnt(15)
    s_waitcnt lgkmcnt(10)
    v_mfma_f32_32x32x16_bf16 v[16:31], v[56:59], v[136:139], v[16:31]
    s_add_u32 s60, s97, 8
    s_and_b32 s60, s60, 15
    s_lshl_b32 s60, s60, 12
    s_add_u32 s60, s60, s77
    buffer_load_dwordx4 v[128:131], v5, s[56:59], s60 offen offset:0 sc1
    s_waitcnt lgkmcnt(8)
    s_nop 0
    v_mfma_f32_32x32x16_bf16 v[32:47], v[60:63], v[136:139], v[32:47]
    ds_read_b64_tr_b16 v[56:57], v14 offset:30720
    ds_read_b64_tr_b16 v[58:59], v14 offset:31744
    ds_read_b64_tr_b16 v[60:61], v15 offset:30720
    ds_read_b64_tr_b16 v[62:63], v15 offset:31744
    s_waitcnt vmcnt(15)
    s_waitcnt lgkmcnt(10)
    v_mfma_f32_32x32x16_bf16 v[16:31], v[64:67], v[140:143], v[16:31]
    buffer_load_dwordx4 v[132:135], v5, s[56:59], s60 offen offset:1024 sc1
    s_waitcnt lgkmcnt(8)
    s_nop 0
    v_mfma_f32_32x32x16_bf16 v[32:47], v[68:71], v[140:143], v[32:47]
    ds_read_b64_tr_b16 v[64:65], v12 offset:48128
    ds_read_b64_tr_b16 v[66:67], v12 offset:49152
    ds_read_b64_tr_b16 v[68:69], v13 offset:48128
    ds_read_b64_tr_b16 v[70:71], v13 offset:49152
    s_waitcnt vmcnt(15)
    s_waitcnt lgkmcnt(10)
    v_mfma_f32_32x32x16_bf16 v[16:31], v[48:51], v[72:75], v[16:31]
    buffer_load_dwordx4 v[136:139], v5, s[56:59], s60 offen offset:2048 sc1
    s_waitcnt lgkmcnt(8)
    s_nop 0
    v_mfma_f32_32x32x16_bf16 v[32:47], v[52:55], v[72:75], v[32:47]
    ds_read_b64_tr_b16 v[48:49], v12 offset:50176
    ds_read_b64_tr_b16 v[50:51], v12 offset:51200
    ds_read_b64_tr_b16 v[52:53], v13 offset:50176
    ds_read_b64_tr_b16 v[54:55], v13 offset:51200
    s_waitcnt vmcnt(15)
    s_waitcnt lgkmcnt(10)
    v_mfma_f32_32x32x16_bf16 v[16:31], v[56:59], v[76:79], v[16:31]
    buffer_load_dwordx4 v[140:143], v5, s[56:59], s60 offen offset:3072 sc1
    s_waitcnt lgkmcnt(8)
    s_nop 0
    v_mfma_f32_32x32x16_bf16 v[32:47], v[60:63], v[76:79], v[32:47]
    ds_read_b64_tr_b16 v[56:57], v12 offset:52224
    ds_read_b64_tr_b16 v[58:59], v12 offset:53248
    ds_read_b64_tr_b16 v[60:61], v13 offset:52224
    ds_read_b64_tr_b16 v[62:63], v13 offset:53248
    s_waitcnt vmcnt(15)
    s_waitcnt lgkmcnt(10)
    v_mfma_f32_32x32x16_bf16 v[16:31], v[64:67], v[80:83], v[16:31]
    s_add_u32 s60, s97, 9
    s_and_b32 s60, s60, 15
    s_lshl_b32 s60, s60, 12
    s_add_u32 s60, s60, s77
    buffer_load_dwordx4 v[72:75], v5, s[56:59], s60 offen offset:0 sc1
    s_waitcnt lgkmcnt(8)
    s_nop 0
    v_mfma_f32_32x32x16_bf16 v[32:47], v[68:71], v[80:83], v[32:47]
    ds_read_b64_tr_b16 v[64:65], v12 offset:54272
    ds_read_b64_tr_b16 v[66:67], v12 offset:55296
    ds_read_b64_tr_b16 v[68:69], v13 offset:54272
    ds_read_b64_tr_b16 v[70:71], v13 offset:55296
    s_waitcnt vmcnt(15)
    s_waitcnt lgkmcnt(10)
    v_mfma_f32_32x32x16_bf16 v[16:31], v[48:51], v[84:87], v[16:31]
    buffer_load_dwordx4 v[76:79], v5, s[56:59], s60 offen offset:1024 sc1
    s_waitcnt lgkmcnt(8)
    s_nop 0
    v_mfma_f32_32x32x16_bf16 v[32:47], v[52:55], v[84:87], v[32:47]
    ds_read_b64_tr_b16 v[48:49], v10 offset:0
    ds_read_b64_tr_b16 v[50:51], v10 offset:1024
    ds_read_b64_tr_b16 v[52:53], v11 offset:0
    ds_read_b64_tr_b16 v[54:55], v11 offset:1024
    s_waitcnt vmcnt(15)
    s_waitcnt lgkmcnt(10)
    v_mfma_f32_32x32x16_bf16 v[16:31], v[56:59], v[88:91], v[16:31]
    buffer_load_dwordx4 v[80:83], v5, s[56:59], s60 offen offset:2048 sc1
    s_waitcnt lgkmcnt(8)
    s_nop 0
    v_mfma_f32_32x32x16_bf16 v[32:47], v[60:63], v[88:91], v[32:47]
    ds_read_b64_tr_b16 v[56:57], v10 offset:2048
    ds_read_b64_tr_b16 v[58:59], v10 offset:3072
    ds_read_b64_tr_b16 v[60:61], v11 offset:2048
    ds_read_b64_tr_b16 v[62:63], v11 offset:3072
    s_waitcnt vmcnt(15)
    s_waitcnt lgkmcnt(10)
    v_mfma_f32_32x32x16_bf16 v[16:31], v[64:67], v[92:95], v[16:31]
    buffer_load_dwordx4 v[84:87], v5, s[56:59], s60 offen offset:3072 sc1
    s_waitcnt lgkmcnt(8)
    s_nop 0
    v_mfma_f32_32x32x16_bf16 v[32:47], v[68:71], v[92:95], v[32:47]
    ds_read_b64_tr_b16 v[64:65], v10 offset:4096
    ds_read_b64_tr_b16 v[66:67], v10 offset:5120
    ds_read_b64_tr_b16 v[68:69], v11 offset:4096
    ds_read_b64_tr_b16 v[70:71], v11 offset:5120
    s_waitcnt vmcnt(15)
    s_waitcnt lgkmcnt(10)
    v_mfma_f32_32x32x16_bf16 v[16:31], v[48:51], v[96:99], v[16:31]
    s_add_u32 s60, s97, 10
    s_and_b32 s60, s60, 15
    s_lshl_b32 s60, s60, 12
    s_add_u32 s60, s60, s77
    buffer_load_dwordx4 v[88:91], v5, s[56:59], s60 offen offset:0 sc1
    s_waitcnt lgkmcnt(8)
    s_nop 0
    v_mfma_f32_32x32x16_bf16 v[32:47], v[52:55], v[96:99], v[32:47]
    ds_read_b64_tr_b16 v[48:49], v10 offset:6144
    ds_read_b64_tr_b16 v[50:51], v10 offset:7168
    ds_read_b64_tr_b16 v[52:53], v11 offset:6144
    ds_read_b64_tr_b16 v[54:55], v11 offset:7168
    s_waitcnt vmcnt(15)
    s_waitcnt lgkmcnt(10)
    v_mfma_f32_32x32x16_bf16 v[16:31], v[56:59], v[100:103], v[16:31]
    buffer_load_dwordx4 v[92:95], v5, s[56:59], s60 offen offset:1024 sc1
    s_waitcnt lgkmcnt(8)
    s_nop 0
    v_mfma_f32_32x32x16_bf16 v[32:47], v[60:63], v[100:103], v[32:47]
    ds_read_b64_tr_b16 v[56:57], v10 offset:8192
    ds_read_b64_tr_b16 v[58:59], v10 offset:9216
    ds_read_b64_tr_b16 v[60:61], v11 offset:8192
    ds_read_b64_tr_b16 v[62:63], v11 offset:9216
    s_waitcnt vmcnt(15)
    s_waitcnt lgkmcnt(10)
    v_mfma_f32_32x32x16_bf16 v[16:31], v[64:67], v[104:107], v[16:31]
    buffer_load_dwordx4 v[96:99], v5, s[56:59], s60 offen offset:2048 sc1
    s_waitcnt lgkmcnt(8)
    s_nop 0
    v_mfma_f32_32x32x16_bf16 v[32:47], v[68:71], v[104:107], v[32:47]
    ds_read_b64_tr_b16 v[64:65], v10 offset:10240
    ds_read_b64_tr_b16 v[66:67], v10 offset:11264
    ds_read_b64_tr_b16 v[68:69], v11 offset:10240
    ds_read_b64_tr_b16 v[70:71], v11 offset:11264
    s_waitcnt vmcnt(15)
    s_waitcnt lgkmcnt(10)
    v_mfma_f32_32x32x16_bf16 v[16:31], v[48:51], v[108:111], v[16:31]
    buffer_load_dwordx4 v[100:103], v5, s[56:59], s60 offen offset:3072 sc1
    s_waitcnt lgkmcnt(8)
    s_nop 0
    v_mfma_f32_32x32x16_bf16 v[32:47], v[52:55], v[108:111], v[32:47]
    ds_read_b64_tr_b16 v[48:49], v10 offset:12288
    ds_read_b64_tr_b16 v[50:51], v10 offset:13312
    ds_read_b64_tr_b16 v[52:53], v11 offset:12288
    ds_read_b64_tr_b16 v[54:55], v11 offset:13312
    s_waitcnt vmcnt(15)
    s_waitcnt lgkmcnt(10)
    v_mfma_f32_32x32x16_bf16 v[16:31], v[56:59], v[112:115], v[16:31]
    s_add_u32 s60, s97, 11
    s_and_b32 s60, s60, 15
    s_lshl_b32 s60, s60, 12
    s_add_u32 s60, s60, s77
    buffer_load_dwordx4 v[104:107], v5, s[56:59], s60 offen offset:0 sc1
    s_waitcnt lgkmcnt(8)
    s_nop 0
    v_mfma_f32_32x32x16_bf16 v[32:47], v[60:63], v[112:115], v[32:47]
    ds_read_b64_tr_b16 v[56:57], v10 offset:14336
    ds_read_b64_tr_b16 v[58:59], v10 offset:15360
    ds_read_b64_tr_b16 v[60:61], v11 offset:14336
    ds_read_b64_tr_b16 v[62:63], v11 offset:15360
    s_waitcnt vmcnt(15)
    s_waitcnt lgkmcnt(10)
    v_mfma_f32_32x32x16_bf16 v[16:31], v[64:67], v[116:119], v[16:31]
    buffer_load_dwordx4 v[108:111], v5, s[56:59], s60 offen offset:1024 sc1
    s_waitcnt lgkmcnt(8)
    s_nop 0
    v_mfma_f32_32x32x16_bf16 v[32:47], v[68:71], v[116:119], v[32:47]
    ds_read_b64_tr_b16 v[64:65], v10 offset:16384
    ds_read_b64_tr_b16 v[66:67], v10 offset:17408
    ds_read_b64_tr_b16 v[68:69], v11 offset:16384
    ds_read_b64_tr_b16 v[70:71], v11 offset:17408
    s_waitcnt vmcnt(15)
    s_waitcnt lgkmcnt(10)
    v_mfma_f32_32x32x16_bf16 v[16:31], v[48:51], v[120:123], v[16:31]
    buffer_load_dwordx4 v[112:115], v5, s[56:59], s60 offen offset:2048 sc1
    s_waitcnt lgkmcnt(8)
    s_nop 0
    v_mfma_f32_32x32x16_bf16 v[32:47], v[52:55], v[120:123], v[32:47]
    ds_read_b64_tr_b16 v[48:49], v10 offset:18432
    ds_read_b64_tr_b16 v[50:51], v10 offset:19456
    ds_read_b64_tr_b16 v[52:53], v11 offset:18432
    ds_read_b64_tr_b16 v[54:55], v11 offset:19456
    s_waitcnt vmcnt(15)
    s_waitcnt lgkmcnt(10)
    v_mfma_f32_32x32x16_bf16 v[16:31], v[56:59], v[124:127], v[16:31]
    buffer_load_dwordx4 v[116:119], v5, s[56:59], s60 offen offset:3072 sc1
    s_waitcnt lgkmcnt(8)
    s_nop 0
    v_mfma_f32_32x32x16_bf16 v[32:47], v[60:63], v[124:127], v[32:47]
    ds_read_b64_tr_b16 v[56:57], v10 offset:20480
    ds_read_b64_tr_b16 v[58:59], v10 offset:21504
    ds_read_b64_tr_b16 v[60:61], v11 offset:20480
    ds_read_b64_tr_b16 v[62:63], v11 offset:21504
    s_waitcnt vmcnt(15)
    s_waitcnt lgkmcnt(10)
    v_mfma_f32_32x32x16_bf16 v[16:31], v[64:67], v[128:131], v[16:31]
    s_add_u32 s60, s97, 12
    s_and_b32 s60, s60, 15
    s_lshl_b32 s60, s60, 12
    s_add_u32 s60, s60, s77
    buffer_load_dwordx4 v[120:123], v5, s[56:59], s60 offen offset:0 sc1
    s_waitcnt lgkmcnt(8)
    s_nop 0
    v_mfma_f32_32x32x16_bf16 v[32:47], v[68:71], v[128:131], v[32:47]
    ds_read_b64_tr_b16 v[64:65], v10 offset:22528
    ds_read_b64_tr_b16 v[66:67], v10 offset:23552
    ds_read_b64_tr_b16 v[68:69], v11 offset:22528
    ds_read_b64_tr_b16 v[70:71], v11 offset:23552
    s_waitcnt vmcnt(15)
    s_waitcnt lgkmcnt(10)
    v_mfma_f32_32x32x16_bf16 v[16:31], v[48:51], v[132:135], v[16:31]
    buffer_load_dwordx4 v[124:127], v5, s[56:59], s60 offen offset:1024 sc1
    s_waitcnt lgkmcnt(8)
    s_nop 0
    v_mfma_f32_32x32x16_bf16 v[32:47], v[52:55], v[132:135], v[32:47]
    ds_read_b64_tr_b16 v[48:49], v10 offset:24576
    ds_read_b64_tr_b16 v[50:51], v10 offset:25600
    ds_read_b64_tr_b16 v[52:53], v11 offset:24576
    ds_read_b64_tr_b16 v[54:55], v11 offset:25600
    s_waitcnt vmcnt(15)
    s_waitcnt lgkmcnt(10)
    v_mfma_f32_32x32x16_bf16 v[16:31], v[56:59], v[136:139], v[16:31]
    buffer_load_dwordx4 v[128:131], v5, s[56:59], s60 offen offset:2048 sc1
    s_waitcnt lgkmcnt(8)
    s_nop 0
    v_mfma_f32_32x32x16_bf16 v[32:47], v[60:63], v[136:139], v[32:47]
    ds_read_b64_tr_b16 v[56:57], v10 offset:26624
    ds_read_b64_tr_b16 v[58:59], v10 offset:27648
    ds_read_b64_tr_b16 v[60:61], v11 offset:26624
    ds_read_b64_tr_b16 v[62:63], v11 offset:27648
    s_waitcnt vmcnt(15)
    s_waitcnt lgkmcnt(10)
    v_mfma_f32_32x32x16_bf16 v[16:31], v[64:67], v[140:143], v[16:31]
    buffer_load_dwordx4 v[132:135], v5, s[56:59], s60 offen offset:3072 sc1
    s_waitcnt lgkmcnt(8)
    s_nop 0
    v_mfma_f32_32x32x16_bf16 v[32:47], v[68:71], v[140:143], v[32:47]
    ds_read_b64_tr_b16 v[64:65], v10 offset:28672
    ds_read_b64_tr_b16 v[66:67], v10 offset:29696
    ds_read_b64_tr_b16 v[68:69], v11 offset:28672
    ds_read_b64_tr_b16 v[70:71], v11 offset:29696
    s_waitcnt vmcnt(15)
    s_waitcnt lgkmcnt(10)
    v_mfma_f32_32x32x16_bf16 v[16:31], v[48:51], v[72:75], v[16:31]
    s_add_u32 s60, s97, 13
    s_and_b32 s60, s60, 15
    s_lshl_b32 s60, s60, 12
    s_add_u32 s60, s60, s77
    buffer_load_dwordx4 v[136:139], v5, s[56:59], s60 offen offset:0 sc1
    s_waitcnt lgkmcnt(8)
    s_nop 0
    v_mfma_f32_32x32x16_bf16 v[32:47], v[52:55], v[72:75], v[32:47]
    ds_read_b64_tr_b16 v[48:49], v10 offset:30720
    ds_read_b64_tr_b16 v[50:51], v10 offset:31744
    ds_read_b64_tr_b16 v[52:53], v11 offset:30720
    ds_read_b64_tr_b16 v[54:55], v11 offset:31744
    s_waitcnt vmcnt(15)
    s_waitcnt lgkmcnt(10)
    v_mfma_f32_32x32x16_bf16 v[16:31], v[56:59], v[76:79], v[16:31]
    buffer_load_dwordx4 v[140:143], v5, s[56:59], s60 offen offset:1024 sc1
    s_waitcnt lgkmcnt(8)
    s_nop 0
    v_mfma_f32_32x32x16_bf16 v[32:47], v[60:63], v[76:79], v[32:47]
    ds_read_b64_tr_b16 v[56:57], v10 offset:32768
    ds_read_b64_tr_b16 v[58:59], v10 offset:33792
    ds_read_b64_tr_b16 v[60:61], v11 offset:32768
    ds_read_b64_tr_b16 v[62:63], v11 offset:33792
    s_waitcnt vmcnt(15)
    s_waitcnt lgkmcnt(10)
    v_mfma_f32_32x32x16_bf16 v[16:31], v[64:67], v[80:83], v[16:31]
    buffer_load_dwordx4 v[72:75], v5, s[56:59], s60 offen offset:2048 sc1
    s_waitcnt lgkmcnt(8)
    s_nop 0
    v_mfma_f32_32x32x16_bf16 v[32:47], v[68:71], v[80:83], v[32:47]
    ds_read_b64_tr_b16 v[64:65], v10 offset:34816
    ds_read_b64_tr_b16 v[66:67], v10 offset:35840
    ds_read_b64_tr_b16 v[68:69], v11 offset:34816
    ds_read_b64_tr_b16 v[70:71], v11 offset:35840
    s_waitcnt vmcnt(15)
    s_waitcnt lgkmcnt(10)
    v_mfma_f32_32x32x16_bf16 v[16:31], v[48:51], v[84:87], v[16:31]
    buffer_load_dwordx4 v[76:79], v5, s[56:59], s60 offen offset:3072 sc1
    s_waitcnt lgkmcnt(8)
    s_nop 0
    v_mfma_f32_32x32x16_bf16 v[32:47], v[52:55], v[84:87], v[32:47]
    ds_read_b64_tr_b16 v[48:49], v10 offset:36864
    ds_read_b64_tr_b16 v[50:51], v10 offset:37888
    ds_read_b64_tr_b16 v[52:53], v11 offset:36864
    ds_read_b64_tr_b16 v[54:55], v11 offset:37888
    s_waitcnt vmcnt(15)
    s_waitcnt lgkmcnt(10)
    v_mfma_f32_32x32x16_bf16 v[16:31], v[56:59], v[88:91], v[16:31]
    s_add_u32 s60, s97, 14
    s_and_b32 s60, s60, 15
    s_lshl_b32 s60, s60, 12
    s_add_u32 s60, s60, s77
    buffer_load_dwordx4 v[80:83], v5, s[56:59], s60 offen offset:0 sc1
    s_waitcnt lgkmcnt(8)
    s_nop 0
    v_mfma_f32_32x32x16_bf16 v[32:47], v[60:63], v[88:91], v[32:47]
    ds_read_b64_tr_b16 v[56:57], v10 offset:38912
    ds_read_b64_tr_b16 v[58:59], v10 offset:39936
    ds_read_b64_tr_b16 v[60:61], v11 offset:38912
    ds_read_b64_tr_b16 v[62:63], v11 offset:39936
    s_waitcnt vmcnt(15)
    s_waitcnt lgkmcnt(10)
    v_mfma_f32_32x32x16_bf16 v[16:31], v[64:67], v[92:95], v[16:31]
    buffer_load_dwordx4 v[84:87], v5, s[56:59], s60 offen offset:1024 sc1
    s_waitcnt lgkmcnt(8)
    v_mfma_f32_32x32x16_bf16 v[32:47], v[68:71], v[92:95], v[32:47]
    s_waitcnt lgkmcnt(0)
    v_mov_b32 v1, 77748
    s_mov_b32 s79, 1048576
k_wo2:
    ds_read_b32 v7, v1
    s_sub_u32 s79, s79, 1
    s_cbranch_scc1 k_wo2_x
    s_waitcnt lgkmcnt(0)
    v_readfirstlane_b32 s78, v7
    s_nop 1
    s_cmp_ge_u32 s78, 4
    s_cbranch_scc1 k_wo2_x
    s_branch k_wo2
k_wo2_x:
    s_waitcnt lgkmcnt(0)
    ds_read_b64_tr_b16 v[64:65], v10 offset:40960
    ds_read_b64_tr_b16 v[66:67], v10 offset:41984
    ds_read_b64_tr_b16 v[68:69], v11 offset:40960
    ds_read_b64_tr_b16 v[70:71], v11 offset:41984
    s_waitcnt vmcnt(15)
    v_mfma_f32_32x32x16_bf16 v[16:31], v[48:51], v[96:99], v[16:31]
    buffer_load_dwordx4 v[88:91], v5, s[56:59], s60 offen offset:2048 sc1
    v_mfma_f32_32x32x16_bf16 v[32:47], v[52:55], v[96:99], v[32:47]
    ds_read_b64_tr_b16 v[48:49], v10 offset:43008
    ds_read_b64_tr_b16 v[50:51], v10 offset:44032
    ds_read_b64_tr_b16 v[52:53], v11 offset:43008
    ds_read_b64_tr_b16 v[54:55], v11 offset:44032
    s_waitcnt vmcnt(15)
    s_nop 0
    v_mfma_f32_32x32x16_bf16 v[16:31], v[56:59], v[100:103], v[16:31]
    buffer_load_dwordx4 v[92:95], v5, s[56:59], s60 offen offset:3072 sc1
    v_mfma_f32_32x32x16_bf16 v[32:47], v[60:63], v[100:103], v[32:47]
    ds_read_b64_tr_b16 v[56:57], v10 offset:45056
    ds_read_b64_tr_b16 v[58:59], v10 offset:46080
    ds_read_b64_tr_b16 v[60:61], v11 offset:45056
    ds_read_b64_tr_b16 v[62:63], v11 offset:46080
    s_waitcnt vmcnt(15)
    s_waitcnt lgkmcnt(10)
    v_mfma_f32_32x32x16_bf16 v[16:31], v[64:67], v[104:107], v[16:31]
    s_add_u32 s60, s97, 15
    s_and_b32 s60, s60, 15
    s_lshl_b32 s60, s60, 12
    s_add_u32 s60, s60, s77
    buffer_load_dwordx4 v[96:99], v5, s[56:59], s60 offen offset:0 sc1
    s_waitcnt lgkmcnt(8)
    s_nop 0
    v_mfma_f32_32x32x16_bf16 v[32:47], v[68:71], v[104:107], v[32:47]
    ds_read_b64_tr_b16 v[64:65], v10 offset:47104
    ds_read_b64_tr_b16 v[66:67], v10 offset:48128
    ds_read_b64_tr_b16 v[68:69], v11 offset:47104
    ds_read_b64_tr_b16 v[70:71], v11 offset:48128
    s_waitcnt vmcnt(15)
    s_waitcnt lgkmcnt(10)
    v_mfma_f32_32x32x16_bf16 v[16:31], v[48:51], v[108:111], v[16:31]
    buffer_load_dwordx4 v[100:103], v5, s[56:59], s60 offen offset:1024 sc1
    s_waitcnt lgkmcnt(8)
    s_nop 0
    v_mfma_f32_32x32x16_bf16 v[32:47], v[52:55], v[108:111], v[32:47]
    ds_read_b64_tr_b16 v[48:49], v10 offset:49152
    ds_read_b64_tr_b16 v[50:51], v10 offset:50176
    ds_read_b64_tr_b16 v[52:53], v11 offset:49152
    ds_read_b64_tr_b16 v[54:55], v11 offset:50176
    s_waitcnt vmcnt(15)
    s_waitcnt lgkmcnt(10)
    v_mfma_f32_32x32x16_bf16 v[16:31], v[56:59], v[112:115], v[16:31]
    buffer_load_dwordx4 v[104:107], v5, s[56:59], s60 offen offset:2048 sc1
    s_waitcnt lgkmcnt(8)
    s_nop 0
    v_mfma_f32_32x32x16_bf16 v[32:47], v[60:63], v[112:115], v[32:47]
    ds_read_b64_tr_b16 v[56:57], v10 offset:51200
    ds_read_b64_tr_b16 v[58:59], v10 offset:52224
    ds_read_b64_tr_b16 v[60:61], v11 offset:51200
    ds_read_b64_tr_b16 v[62:63], v11 offset:52224
    s_waitcnt vmcnt(15)
    s_waitcnt lgkmcnt(10)
    v_mfma_f32_32x32x16_bf16 v[16:31], v[64:67], v[116:119], v[16:31]
    buffer_load_dwordx4 v[108:111], v5, s[56:59], s60 offen offset:3072 sc1
    s_waitcnt lgkmcnt(8)
    v_mfma_f32_32x32x16_bf16 v[32:47], v[68:71], v[116:119], v[32:47]
    s_waitcnt lgkmcnt(0)
    v_mov_b32 v1, 77760
    v_mov_b32 v7, 1
    s_mov_b64 exec, 1
    ds_add_u32 v1, v7
    s_mov_b64 exec, -1
    ds_read_b64_tr_b16 v[64:65], v10 offset:53248
    ds_read_b64_tr_b16 v[66:67], v10 offset:54272
    ds_read_b64_tr_b16 v[68:69], v11 offset:53248
    ds_read_b64_tr_b16 v[70:71], v11 offset:54272
    s_waitcnt vmcnt(15)
    v_mfma_f32_32x32x16_bf16 v[16:31], v[48:51], v[120:123], v[16:31]
    v_mfma_f32_32x32x16_bf16 v[32:47], v[52:55], v[120:123], v[32:47]
    ds_read_b64_tr_b16 v[48:49], v10 offset:55296
    ds_read_b64_tr_b16 v[50:51], v10 offset:56320
    ds_read_b64_tr_b16 v[52:53], v11 offset:55296
    ds_read_b64_tr_b16 v[54:55], v11 offset:56320
    s_waitcnt vmcnt(14)
    s_nop 0
    v_mfma_f32_32x32x16_bf16 v[16:31], v[56:59], v[124:127], v[16:31]
    v_mfma_f32_32x32x16_bf16 v[32:47], v[60:63], v[124:127], v[32:47]
    ds_read_b64_tr_b16 v[56:57], v10 offset:57344
    ds_read_b64_tr_b16 v[58:59], v10 offset:58368
    ds_read_b64_tr_b16 v[60:61], v11 offset:57344
    ds_read_b64_tr_b16 v[62:63], v11 offset:58368
    s_waitcnt vmcnt(13)
    s_waitcnt lgkmcnt(10)
    v_mfma_f32_32x32x16_bf16 v[16:31], v[64:67], v[128:131], v[16:31]
    s_waitcnt lgkmcnt(8)
    s_nop 0
    v_mfma_f32_32x32x16_bf16 v[32:47], v[68:71], v[128:131], v[32:47]
    ds_read_b64_tr_b16 v[64:65], v10 offset:59392
    ds_read_b64_tr_b16 v[66:67], v10 offset:60416
    ds_read_b64_tr_b16 v[68:69], v11 offset:59392
    ds_read_b64_tr_b16 v[70:71], v11 offset:60416
    s_waitcnt vmcnt(12)
    s_waitcnt lgkmcnt(10)
    v_mfma_f32_32x32x16_bf16 v[16:31], v[48:51], v[132:135], v[16:31]
    s_waitcnt lgkmcnt(8)
    s_nop 0
    v_mfma_f32_32x32x16_bf16 v[32:47], v[52:55], v[132:135], v[32:47]
    ds_read_b64_tr_b16 v[48:49], v10 offset:61440
    ds_read_b64_tr_b16 v[50:51], v10 offset:62464
    ds_read_b64_tr_b16 v[52:53], v11 offset:61440
    ds_read_b64_tr_b16 v[54:55], v11 offset:62464
    s_waitcnt vmcnt(11)
    s_waitcnt lgkmcnt(10)
    v_mfma_f32_32x32x16_bf16 v[16:31], v[56:59], v[136:139], v[16:31]
    s_waitcnt lgkmcnt(8)
    s_nop 0
    v_mfma_f32_32x32x16_bf16 v[32:47], v[60:63], v[136:139], v[32:47]
    ds_read_b64_tr_b16 v[56:57], v10 offset:63488
    ds_read_b64_tr_b16 v[58:59], v10 offset:64512
    ds_read_b64_tr_b16 v[60:61], v11 offset:63488
    ds_read_b64_tr_b16 v[62:63], v11 offset:64512
    s_waitcnt vmcnt(10)
    s_waitcnt lgkmcnt(10)
    v_mfma_f32_32x32x16_bf16 v[16:31], v[64:67], v[140:143], v[16:31]
    s_waitcnt lgkmcnt(8)
    s_nop 0
    v_mfma_f32_32x32x16_bf16 v[32:47], v[68:71], v[140:143], v[32:47]
    ds_read_b64_tr_b16 v[64:65], v12 offset:0
    ds_read_b64_tr_b16 v[66:67], v12 offset:1024
    ds_read_b64_tr_b16 v[68:69], v13 offset:0
    ds_read_b64_tr_b16 v[70:71], v13 offset:1024
    s_waitcnt vmcnt(9)
    s_waitcnt lgkmcnt(10)
    v_mfma_f32_32x32x16_bf16 v[16:31], v[48:51], v[72:75], v[16:31]
    s_waitcnt lgkmcnt(8)
    s_nop 0
    v_mfma_f32_32x32x16_bf16 v[32:47], v[52:55], v[72:75], v[32:47]
    ds_read_b64_tr_b16 v[48:49], v12 offset:2048
    ds_read_b64_tr_b16 v[50:51], v12 offset:3072
    ds_read_b64_tr_b16 v[52:53], v13 offset:2048
    ds_read_b64_tr_b16 v[54:55], v13 offset:3072
    s_waitcnt vmcnt(8)
    s_waitcnt lgkmcnt(10)
    v_mfma_f32_32x32x16_bf16 v[16:31], v[56:59], v[76:79], v[16:31]
    s_waitcnt lgkmcnt(8)
    s_nop 0
    v_mfma_f32_32x32x16_bf16 v[32:47], v[60:63], v[76:79], v[32:47]
    ds_read_b64_tr_b16 v[56:57], v12 offset:4096
    ds_read_b64_tr_b16 v[58:59], v12 offset:5120
    ds_read_b64_tr_b16 v[60:61], v13 offset:4096
    ds_read_b64_tr_b16 v[62:63], v13 offset:5120
    s_waitcnt vmcnt(7)
    s_waitcnt lgkmcnt(10)
    v_mfma_f32_32x32x16_bf16 v[16:31], v[64:67], v[80:83], v[16:31]
    s_waitcnt lgkmcnt(8)
    s_nop 0
    v_mfma_f32_32x32x16_bf16 v[32:47], v[68:71], v[80:83], v[32:47]
    ds_read_b64_tr_b16 v[64:65], v12 offset:6144
    ds_read_b64_tr_b16 v[66:67], v12 offset:7168
    ds_read_b64_tr_b16 v[68:69], v13 offset:6144
    ds_read_b64_tr_b16 v[70:71], v13 offset:7168
    s_waitcnt vmcnt(6)
    s_waitcnt lgkmcnt(10)
    v_mfma_f32_32x32x16_bf16 v[16:31], v[48:51], v[84:87], v[16:31]
    s_waitcnt lgkmcnt(8)
    s_nop 0
    v_mfma_f32_32x32x16_bf16 v[32:47], v[52:55], v[84:87], v[32:47]
    ds_read_b64_tr_b16 v[48:49], v12 offset:29696
    ds_read_b64_tr_b16 v[50:51], v12 offset:30720
    ds_read_b64_tr_b16 v[52:53], v13 offset:29696
    ds_read_b64_tr_b16 v[54:55], v13 offset:30720
    s_waitcnt vmcnt(5)
    s_waitcnt lgkmcnt(10)
    v_mfma_f32_32x32x16_bf16 v[16:31], v[56:59], v[88:91], v[16:31]
    s_waitcnt lgkmcnt(8)
    s_nop 0
    v_mfma_f32_32x32x16_bf16 v[32:47], v[60:63], v[88:91], v[32:47]
    ds_read_b64_tr_b16 v[56:57], v12 offset:31744
    ds_read_b64_tr_b16 v[58:59], v12 offset:32768
    ds_read_b64_tr_b16 v[60:61], v13 offset:31744
    ds_read_b64_tr_b16 v[62:63], v13 offset:32768
    s_waitcnt vmcnt(4)
    s_waitcnt lgkmcnt(10)
    v_mfma_f32_32x32x16_bf16 v[16:31], v[64:67], v[92:95], v[16:31]
    s_waitcnt lgkmcnt(8)
    s_nop 0
    v_mfma_f32_32x32x16_bf16 v[32:47], v[68:71], v[92:95], v[32:47]
    ds_read_b64_tr_b16 v[64:65], v12 offset:33792
    ds_read_b64_tr_b16 v[66:67], v12 offset:34816
    ds_read_b64_tr_b16 v[68:69], v13 offset:33792
    ds_read_b64_tr_b16 v[70:71], v13 offset:34816
    s_waitcnt vmcnt(3)
    s_waitcnt lgkmcnt(10)
    v_mfma_f32_32x32x16_bf16 v[16:31], v[48:51], v[96:99], v[16:31]
    s_waitcnt lgkmcnt(8)
    s_nop 0
    v_mfma_f32_32x32x16_bf16 v[32:47], v[52:55], v[96:99], v[32:47]
    ds_read_b64_tr_b16 v[48:49], v12 offset:35840
    ds_read_b64_tr_b16 v[50:51], v12 offset:36864
    ds_read_b64_tr_b16 v[52:53], v13 offset:35840
    ds_read_b64_tr_b16 v[54:55], v13 offset:36864
    s_waitcnt vmcnt(2)
    s_waitcnt lgkmcnt(10)
    v_mfma_f32_32x32x16_bf16 v[16:31], v[56:59], v[100:103], v[16:31]
    s_waitcnt lgkmcnt(8)
    v_mfma_f32_32x32x16_bf16 v[32:47], v[60:63], v[100:103], v[32:47]
    s_waitcnt vmcnt(1)
    s_waitcnt lgkmcnt(6)
    v_mfma_f32_32x32x16_bf16 v[16:31], v[64:67], v[104:107], v[16:31]
    s_waitcnt lgkmcnt(4)
    v_mfma_f32_32x32x16_bf16 v[32:47], v[68:71], v[104:107], v[32:47]
    s_waitcnt vmcnt(0)
    s_waitcnt lgkmcnt(2)
    v_mfma_f32_32x32x16_bf16 v[16:31], v[48:51], v[108:111], v[16:31]
    s_waitcnt lgkmcnt(0)
    v_mfma_f32_32x32x16_bf16 v[32:47], v[52:55], v[108:111], v[32:47]
    s_mov_b32 s4, s30
    s_mov_b32 s5, s31
    s_mov_b32 s6, 8388608
    s_mov_b32 s7, 0x20000
    s_lshl_b32 s64, s40, 12
    s_add_u32 s64, s64, 77824
    v_and_b32 v13, 31, v0
    v_lshl_add_u32 v14, v13, 7, s64
    v_and_b32 v13, 7, v13
    v_lshlrev_b32 v15, 1, v8
    v_xor_b32 v13, v13, v15
    v_lshrrev_b32 v1, 3, v0
    v_and_b32 v2, 7, v0
    v_cvt_pk_bf16_f32 v64, v16, v17
    v_cvt_pk_bf16_f32 v65, v18, v19
    v_cvt_pk_bf16_f32 v66, v20, v21
    v_cvt_pk_bf16_f32 v67, v22, v23
    v_cvt_pk_bf16_f32 v68, v24, v25
    v_cvt_pk_bf16_f32 v69, v26, v27
    v_cvt_pk_bf16_f32 v70, v28, v29
    v_cvt_pk_bf16_f32 v71, v30, v31
    v_xor_b32 v15, 0, v13
    v_lshl_add_u32 v15, v15, 4, v14
    ds_write_b128 v15, v[64:67]
    v_xor_b32 v15, 1, v13
    v_lshl_add_u32 v15, v15, 4, v14
    ds_write_b128 v15, v[68:71]
    v_cvt_pk_bf16_f32 v72, v32, v33
    v_cvt_pk_bf16_f32 v73, v34, v35
    v_cvt_pk_bf16_f32 v74, v36, v37
    v_cvt_pk_bf16_f32 v75, v38, v39
    v_cvt_pk_bf16_f32 v76, v40, v41
    v_cvt_pk_bf16_f32 v77, v42, v43
    v_cvt_pk_bf16_f32 v78, v44, v45
    v_cvt_pk_bf16_f32 v79, v46, v47
    v_xor_b32 v15, 4, v13
    v_lshl_add_u32 v15, v15, 4, v14
    ds_write_b128 v15, v[72:75]
    v_xor_b32 v15, 5, v13
    v_lshl_add_u32 v15, v15, 4, v14
    ds_write_b128 v15, v[76:79]
    v_xor_b32 v13, v1, v2
    v_lshlrev_b32 v13, 4, v13
    v_lshl_add_u32 v13, v1, 7, v13
    v_add_u32 v13, s64, v13
    s_lshl_b32 s64, s100, 19
    s_lshl_b32 s65, s40, 17
    s_add_u32 s64, s64, s65
    s_lshl_b32 s65, s101, 7
    s_add_u32 s64, s64, s65
    v_lshlrev_b32 v14, 12, v1
    v_lshl_add_u32 v14, v2, 4, v14
    s_waitcnt lgkmcnt(0)
    ds_read_b128 v[80:83], v13 offset:0
    ds_read_b128 v[84:87], v13 offset:1024
    ds_read_b128 v[88:91], v13 offset:2048
    ds_read_b128 v[92:95], v13 offset:3072
    s_waitcnt lgkmcnt(3)
    buffer_store_dwordx4 v[80:83], v14, s[4:7], s64 offen
    s_add_u32 s64, s64, 32768
    s_waitcnt lgkmcnt(2)
    buffer_store_dwordx4 v[84:87], v14, s[4:7], s64 offen
    s_add_u32 s64, s64, 32768
    s_waitcnt lgkmcnt(1)
    buffer_store_dwordx4 v[88:91], v14, s[4:7], s64 offen
    s_add_u32 s64, s64, 32768
    s_waitcnt lgkmcnt(0)
    buffer_store_dwordx4 v[92:95], v14, s[4:7], s64 offen
    s_endpgm
k_s:
    s_sub_u32 s41, s40, 4
    v_lshrrev_b32 v1, 3, v0
    s_lshl_b32 s42, s41, 5
    v_add_u32 v5, s42, v1
    v_lshlrev_b32 v5, 11, v5
    v_and_b32 v2, 7, v0
    v_lshrrev_b32 v3, 4, v0
    v_xor_b32 v4, 0, v3
    v_xor_b32 v4, v4, v2
    v_lshl_add_u32 v4, v4, 4, v5
    v_add_u32 v8, 0, v4
    v_xor_b32 v4, 4, v3
    v_xor_b32 v4, v4, v2
    v_lshl_add_u32 v4, v4, 4, v5
    v_add_u32 v9, 15360, v4
    v_xor_b32 v4, 0, v3
    v_xor_b32 v4, v4, v2
    v_lshl_add_u32 v4, v4, 4, v5
    v_add_u32 v10, 30720, v4
    v_xor_b32 v4, 4, v3
    v_xor_b32 v4, v4, v2
    v_lshl_add_u32 v4, v4, 4, v5
    v_add_u32 v11, 46080, v4
    s_lshl_b32 s42, s41, 4
    v_add_u32 v19, s42, v1
    v_mul_u32_u24 v5, 6144, v19
    s_lshl_b32 s42, s38, 7
    v_add_u32 v5, s42, v5
    v_bfe_u32 v3, v0, 4, 1
    v_lshlrev_b32 v4, 2, v3
    v_xor_b32 v6, v4, v2
    v_lshl_add_u32 v4, v6, 4, v5
    v_add_u32 v12, 0, v4
    v_add_u32 v14, 0, v4
    v_add_u32 v16, 4096, v4
    v_add_u32 v13, 48128, v4
    v_add_u32 v15, 48128, v4
    v_add_u32 v17, 52224, v4
    s_lshl_b32 s43, s41, 12
    s_mul_i32 s44, s41, 6144
    s_add_u32 s44, s44, 16384
    s_lshr_b32 s45, s37, 2
    s_add_u32 s45, s45, s37
    s_lshl_b32 s46, s39, 18
    s_waitcnt lgkmcnt(0)
    s_add_u32 s48, s4, s46
    s_addc_u32 s49, s5, 0
    s_mov_b32 s50, 262144
    s_mov_b32 s51, 0x20000
    s_mov_b32 s64, s6
    s_mov_b32 s65, s7
    s_mov_b32 s66, 6291456
    s_mov_b32 s67, 0x20000
    s_lshl_b32 s47, s36, 5
    s_add_u32 s47, s47, s37
    s_lshl_b32 s47, s47, 2
    s_add_u32 s47, s47, s41
    v_and_b32 v18, 31, v0
    s_lshl_b32 s60, s47, 8
    v_lshl_add_u32 v4, v18, 3, s60
    s_lshl_b32 s60, s47, 1
    v_mov_b32 v5, s60
    s_add_u32 s60, s45, 0
    s_and_b32 s60, s60, 3
    s_lshl_b32 s61, s60, 7
    s_mul_i32 s62, s60, 393216
    s_add_u32 m0, s43, 0
    s_nop 0
    buffer_load_dwordx4 v8, s[48:51], s61 offen offset:0 lds
    buffer_load_dwordx4 v9, s[48:51], s61 offen offset:1024 lds
    buffer_load_dwordx4 v10, s[48:51], s61 offen offset:2048 lds
    buffer_load_dwordx4 v11, s[48:51], s61 offen offset:3072 lds
    s_add_u32 m0, s44, 0
    s_nop 0
    s_nop 0
    buffer_load_dwordx4 v12, s[64:67], s62 offen offset:0 lds
    buffer_load_dwordx4 v13, s[64:67], s62 offen offset:1024 lds
    buffer_load_dwordx4 v14, s[64:67], s62 offen offset:2048 lds
    buffer_load_dwordx4 v15, s[64:67], s62 offen offset:3072 lds
    s_add_u32 m0, s44, 4096
    s_nop 0
    s_nop 0
    buffer_load_dwordx4 v16, s[64:67], s62 offen offset:0 lds
    buffer_load_dwordx4 v17, s[64:67], s62 offen offset:1024 lds
    global_load_ushort v234, v5, s[26:27]
    global_load_dword v228, v4, s[14:15] offset:4
    global_load_dword v229, v4, s[16:17] offset:4
    global_load_dword v230, v4, s[18:19] offset:4
    global_load_dword v231, v4, s[20:21] offset:4
    global_load_dword v232, v4, s[22:23] offset:4
    global_load_dword v233, v4, s[24:25] offset:4
    global_load_ushort v22, v5, s[28:29]
    s_lshl_b32 s20, s69, 18
    s_lshl_b32 s71, s68, 7
    s_add_u32 s20, s20, s71
    s_lshl_b32 s71, s41, 16
    s_add_u32 s20, s20, s71
    v_lshlrev_b32 v24, 11, v1
    v_lshl_add_u32 v24, v2, 4, v24
    s_lshl_b32 s21, s41, 12
    s_add_u32 s21, s21, 126976
    s_mov_b32 s24, s12
    s_mov_b32 s25, s13
    s_mov_b32 s26, 4194304
    s_mov_b32 s27, 0x20000
    s_mov_b32 m0, s21
    s_nop 0
    s_nop 0
    buffer_load_dwordx4 v24, s[24:27], s20 offen offset:0 lds
    s_add_u32 s20, s20, 15360
    buffer_load_dwordx4 v24, s[24:27], s20 offen offset:1024 lds
    s_add_u32 s20, s20, 15360
    buffer_load_dwordx4 v24, s[24:27], s20 offen offset:2048 lds
    s_add_u32 s20, s20, 15360
    buffer_load_dwordx4 v24, s[24:27], s20 offen offset:3072 lds
    s_setprio 3
    v_lshrrev_b32 v3, 5, v0
    v_lshlrev_b32 v176, 2, v3
    v_sub_u32 v176, v18, v176
    v_mov_b32 v177, 0x3f80
    v_mov_b32 v178, 0x3f800000
    v_cmp_eq_u32 vcc, 0, v176
    v_cmp_eq_u32 s[98:99], 1, v176
    s_nop 0
    v_cndmask_b32 v236, 0, v177, vcc
    v_cndmask_b32 v236, v236, v178, s[98:99]
    v_cmp_eq_u32 vcc, 2, v176
    v_cmp_eq_u32 s[98:99], 3, v176
    s_nop 0
    v_cndmask_b32 v237, 0, v177, vcc
    v_cndmask_b32 v237, v237, v178, s[98:99]
    v_cmp_eq_u32 vcc, 8, v176
    v_cmp_eq_u32 s[98:99], 9, v176
    s_nop 0
    v_cndmask_b32 v238, 0, v177, vcc
    v_cndmask_b32 v238, v238, v178, s[98:99]
    v_cmp_eq_u32 vcc, 10, v176
    v_cmp_eq_u32 s[98:99], 11, v176
    s_nop 0
    v_cndmask_b32 v239, 0, v177, vcc
    v_cndmask_b32 v239, v239, v178, s[98:99]
    v_cmp_eq_u32 vcc, 16, v176
    v_cmp_eq_u32 s[98:99], 17, v176
    s_nop 0
    v_cndmask_b32 v240, 0, v177, vcc
    v_cndmask_b32 v240, v240, v178, s[98:99]
    v_cmp_eq_u32 vcc, 18, v176
    v_cmp_eq_u32 s[98:99], 19, v176
    s_nop 0
    v_cndmask_b32 v241, 0, v177, vcc
    v_cndmask_b32 v241, v241, v178, s[98:99]
    v_cmp_eq_u32 vcc, 24, v176
    v_cmp_eq_u32 s[98:99], 25, v176
    s_nop 0
    v_cndmask_b32 v242, 0, v177, vcc
    v_cndmask_b32 v242, v242, v178, s[98:99]
    v_cmp_eq_u32 vcc, 26, v176
    v_cmp_eq_u32 s[98:99], 27, v176
    s_nop 0
    v_cndmask_b32 v243, 0, v177, vcc
    v_cndmask_b32 v243, v243, v178, s[98:99]
    s_add_u32 s0, s34, 15466496
    s_addc_u32 s1, s35, 0
    s_load_dword s53, s[0:1], 0
    s_mov_b32 s56, s34
    s_mov_b32 s57, s35
    s_mov_b32 s58, 268435456
    s_mov_b32 s59, 0x20000
    v_lshrrev_b32 v39, 4, v0
    v_bfe_u32 v4, v0, 2, 2
    v_lshl_add_u32 v4, v39, 3, v4
    v_lshlrev_b32 v4, 7, v4
    v_and_b32 v40, 3, v0
    v_lshl_add_u32 v4, v40, 3, v4
    v_add_u32 v25, s21, v4
    v_and_b32 v4, 15, v0
    v_lshlrev_b32 v26, 12, v4
    v_lshl_add_u32 v26, v39, 4, v26
    s_lshl_b32 s70, s68, 18
    s_lshl_b32 s71, s69, 8
    s_add_u32 s70, s70, s71
    s_lshl_b32 s71, s41, 6
    s_add_u32 s70, s70, s71
    s_lshl_b32 s60, s2, 2
    s_add_u32 s60, s60, s41
    s_lshl_b32 s61, s60, 7
    s_lshl_b32 s60, s60, 11
    v_lshl_add_u32 v35, v4, 7, s60
    s_add_u32 s61, s61, 14942208
    v_mov_b32 v34, s61
    v_lshlrev_b32 v19, 11, v19
    v_lshl_add_u32 v19, v6, 4, v19
    s_lshl_b32 s42, s101, 7
    v_add_u32_e64 v19, s42, v19
    v_add_u32 v20, 15360, v19
    s_mul_i32 s74, s41, 9216
    s_add_u32 s74, s74, 40960
    s_mul_i32 s63, s41, 4608
    s_add_u32 s63, s63, 95232
    v_lshrrev_b32 v3, 5, v0
    v_cmp_eq_u32 s[72:73], 1, v3
    v_cmp_eq_u32 vcc, 0, v0
    v_lshlrev_b32 v5, 4, v0
    s_lshl_b32 s60, s41, 12
    s_add_u32 s60, s60, 143360
    v_add_u32 v21, s60, v5
    v_min_u32 v36, 29, v0
    v_lshl_add_u32 v36, v36, 4, s63
    v_add_u32 v37, s63, v5
    v_lshlrev_b32 v38, 7, v4
    s_lshl_b32 s22, s68, 11
    s_add_u32 s22, s22, 15007744
    s_lshl_b32 s23, s69, 7
    s_add_u32 s23, s23, s22
    v_mov_b32 v28, 0
    v_mov_b32 v29, 0
    v_mov_b32 v30, 0
    v_mov_b32 v31, 0
    s_mov_b32 s8, s10
    s_mov_b32 s9, s11
    s_mov_b32 s10, 2097152
    s_mov_b32 s11, 0x20000
    s_lshl_b32 s3, s41, 11
    s_waitcnt lgkmcnt(0)
    s_add_u32 s53, s53, 1
    s_setprio 0
    s_add_u32 s60, s45, 1
    s_and_b32 s60, s60, 3
    s_lshl_b32 s61, s60, 7
    s_mul_i32 s62, s60, 393216
    s_add_u32 m0, s43, 40960
    s_nop 0
    s_nop 0
    buffer_load_dwordx4 v8, s[48:51], s61 offen offset:0 lds
    buffer_load_dwordx4 v9, s[48:51], s61 offen offset:1024 lds
    buffer_load_dwordx4 v10, s[48:51], s61 offen offset:2048 lds
    buffer_load_dwordx4 v11, s[48:51], s61 offen offset:3072 lds
    s_add_u32 m0, s44, 40960
    s_nop 0
    s_nop 0
    buffer_load_dwordx4 v12, s[64:67], s62 offen offset:0 lds
    buffer_load_dwordx4 v13, s[64:67], s62 offen offset:1024 lds
    buffer_load_dwordx4 v14, s[64:67], s62 offen offset:2048 lds
    buffer_load_dwordx4 v15, s[64:67], s62 offen offset:3072 lds
    s_add_u32 m0, s44, 45056
    s_nop 0
    buffer_load_dwordx4 v16, s[64:67], s62 offen offset:0 lds
    buffer_load_dwordx4 v17, s[64:67], s62 offen offset:1024 lds
    s_waitcnt vmcnt(22)
    s_barrier
    s_add_u32 s60, s45, 2
    s_and_b32 s60, s60, 3
    s_lshl_b32 s61, s60, 7
    s_mul_i32 s62, s60, 393216
    s_add_u32 m0, s43, 81920
    s_nop 0
    s_nop 0
    buffer_load_dwordx4 v8, s[48:51], s61 offen offset:0 lds
    buffer_load_dwordx4 v9, s[48:51], s61 offen offset:1024 lds
    buffer_load_dwordx4 v10, s[48:51], s61 offen offset:2048 lds
    buffer_load_dwordx4 v11, s[48:51], s61 offen offset:3072 lds
    s_add_u32 m0, s44, 81920
    s_nop 0
    s_nop 0
    buffer_load_dwordx4 v12, s[64:67], s62 offen offset:0 lds
    buffer_load_dwordx4 v13, s[64:67], s62 offen offset:1024 lds
    buffer_load_dwordx4 v14, s[64:67], s62 offen offset:2048 lds
    buffer_load_dwordx4 v15, s[64:67], s62 offen offset:3072 lds
    s_add_u32 m0, s44, 86016
    s_nop 0
    s_nop 0
    buffer_load_dwordx4 v16, s[64:67], s62 offen offset:0 lds
    buffer_load_dwordx4 v17, s[64:67], s62 offen offset:1024 lds
    buffer_load_dword v23, v35, s[8:11], 0 offen
    buffer_load_dword v23, v34, s[56:59], 0 offen
    ds_read_b128 v[108:111], v21 offset:0
    ds_read_b128 v[112:115], v21 offset:1024
    ds_read_b128 v[116:119], v21 offset:2048
    ds_read_b128 v[120:123], v21 offset:3072
    s_waitcnt vmcnt(12)
    s_barrier
    s_add_u32 s60, s45, 3
    s_and_b32 s60, s60, 3
    s_lshl_b32 s61, s60, 7
    s_mul_i32 s62, s60, 393216
    s_add_u32 m0, s43, 0
    s_nop 0
    buffer_load_dwordx4 v8, s[48:51], s61 offen offset:0 lds
    buffer_load_dwordx4 v9, s[48:51], s61 offen offset:1024 lds
    buffer_load_dwordx4 v10, s[48:51], s61 offen offset:2048 lds
    buffer_load_dwordx4 v11, s[48:51], s61 offen offset:3072 lds
    s_add_u32 m0, s44, 0
    s_nop 0
    s_nop 0
    buffer_load_dwordx4 v12, s[64:67], s62 offen offset:0 lds
    buffer_load_dwordx4 v13, s[64:67], s62 offen offset:1024 lds
    buffer_load_dwordx4 v14, s[64:67], s62 offen offset:2048 lds
    buffer_load_dwordx4 v15, s[64:67], s62 offen offset:3072 lds
    s_add_u32 m0, s44, 4096
    s_nop 0
    buffer_load_dwordx4 v16, s[64:67], s62 offen offset:0 lds
    buffer_load_dwordx4 v17, s[64:67], s62 offen offset:1024 lds
    v_lshlrev_b32 v22, 16, v22
    v_cndmask_b32 v22, 0, v22, vcc
    s_waitcnt vmcnt(12)
    s_barrier
    s_add_u32 s60, s45, 0
    s_and_b32 s60, s60, 3
    s_or_b32 s60, s60, 4
    s_lshl_b32 s61, s60, 7
    s_mul_i32 s62, s60, 393216
    s_add_u32 m0, s43, 40960
    s_nop 0
    buffer_load_dwordx4 v8, s[48:51], s61 offen offset:0 lds
    buffer_load_dwordx4 v9, s[48:51], s61 offen offset:1024 lds
    buffer_load_dwordx4 v10, s[48:51], s61 offen offset:2048 lds
    buffer_load_dwordx4 v11, s[48:51], s61 offen offset:3072 lds
    s_add_u32 m0, s44, 40960
    s_nop 0
    s_nop 0
    buffer_load_dwordx4 v12, s[64:67], s62 offen offset:0 lds
    buffer_load_dwordx4 v13, s[64:67], s62 offen offset:1024 lds
    buffer_load_dwordx4 v14, s[64:67], s62 offen offset:2048 lds
    buffer_load_dwordx4 v15, s[64:67], s62 offen offset:3072 lds
    s_add_u32 m0, s44, 45056
    s_nop 0
    s_nop 0
    buffer_load_dwordx4 v16, s[64:67], s62 offen offset:0 lds
    buffer_load_dwordx4 v17, s[64:67], s62 offen offset:1024 lds
    ds_read_b64_tr_b16 v[128:129], v25 offset:0
    ds_read_b64_tr_b16 v[130:131], v25 offset:512
    ds_read_b64_tr_b16 v[132:133], v25 offset:32
    ds_read_b64_tr_b16 v[134:135], v25 offset:544
    ds_read_b64_tr_b16 v[136:137], v25 offset:64
    ds_read_b64_tr_b16 v[138:139], v25 offset:576
    ds_read_b64_tr_b16 v[140:141], v25 offset:96
    ds_read_b64_tr_b16 v[142:143], v25 offset:608
    s_waitcnt vmcnt(10)
    s_barrier
    s_add_u32 s60, s45, 1
    s_and_b32 s60, s60, 3
    s_or_b32 s60, s60, 4
    s_lshl_b32 s61, s60, 7
    s_mul_i32 s62, s60, 393216
    s_add_u32 m0, s43, 81920
    s_nop 0
    s_nop 0
    buffer_load_dwordx4 v8, s[48:51], s61 offen offset:0 lds
    buffer_load_dwordx4 v9, s[48:51], s61 offen offset:1024 lds
    buffer_load_dwordx4 v10, s[48:51], s61 offen offset:2048 lds
    buffer_load_dwordx4 v11, s[48:51], s61 offen offset:3072 lds
    s_add_u32 m0, s44, 81920
    s_nop 0
    s_nop 0
    buffer_load_dwordx4 v12, s[64:67], s62 offen offset:0 lds
    buffer_load_dwordx4 v13, s[64:67], s62 offen offset:1024 lds
    buffer_load_dwordx4 v14, s[64:67], s62 offen offset:2048 lds
    buffer_load_dwordx4 v15, s[64:67], s62 offen offset:3072 lds
    s_add_u32 m0, s44, 86016
    s_nop 0
    buffer_load_dwordx4 v16, s[64:67], s62 offen offset:0 lds
    buffer_load_dwordx4 v17, s[64:67], s62 offen offset:1024 lds
    s_waitcnt lgkmcnt(0)
    s_waitcnt vmcnt(10)
    s_barrier
    s_add_u32 s60, s45, 2
    s_and_b32 s60, s60, 3
    s_or_b32 s60, s60, 4
    s_lshl_b32 s61, s60, 7
    s_mul_i32 s62, s60, 393216
    s_add_u32 m0, s43, 0
    s_nop 0
    buffer_load_dwordx4 v8, s[48:51], s61 offen offset:0 lds
    buffer_load_dwordx4 v9, s[48:51], s61 offen offset:1024 lds
    buffer_load_dwordx4 v10, s[48:51], s61 offen offset:2048 lds
    buffer_load_dwordx4 v11, s[48:51], s61 offen offset:3072 lds
    s_add_u32 m0, s44, 0
    s_nop 0
    buffer_load_dwordx4 v12, s[64:67], s62 offen offset:0 lds
    buffer_load_dwordx4 v13, s[64:67], s62 offen offset:1024 lds
    buffer_load_dwordx4 v14, s[64:67], s62 offen offset:2048 lds
    buffer_load_dwordx4 v15, s[64:67], s62 offen offset:3072 lds
    s_add_u32 m0, s44, 4096
    s_nop 0
    buffer_load_dwordx4 v16, s[64:67], s62 offen offset:0 lds
    buffer_load_dwordx4 v17, s[64:67], s62 offen offset:1024 lds
    s_waitcnt vmcnt(10)
    s_barrier
    s_add_u32 s60, s45, 3
    s_and_b32 s60, s60, 3
    s_or_b32 s60, s60, 4
    s_lshl_b32 s61, s60, 7
    s_mul_i32 s62, s60, 393216
    s_add_u32 m0, s43, 40960
    s_nop 0
    buffer_load_dwordx4 v8, s[48:51], s61 offen offset:0 lds
    buffer_load_dwordx4 v9, s[48:51], s61 offen offset:1024 lds
    buffer_load_dwordx4 v10, s[48:51], s61 offen offset:2048 lds
    buffer_load_dwordx4 v11, s[48:51], s61 offen offset:3072 lds
    s_add_u32 m0, s44, 40960
    s_nop 0
    s_nop 0
    buffer_load_dwordx4 v12, s[64:67], s62 offen offset:0 lds
    buffer_load_dwordx4 v13, s[64:67], s62 offen offset:1024 lds
    buffer_load_dwordx4 v14, s[64:67], s62 offen offset:2048 lds
    buffer_load_dwordx4 v15, s[64:67], s62 offen offset:3072 lds
    s_add_u32 m0, s44, 45056
    s_nop 0
    buffer_load_dwordx4 v16, s[64:67], s62 offen offset:0 lds
    buffer_load_dwordx4 v17, s[64:67], s62 offen offset:1024 lds
    s_waitcnt vmcnt(10)
    s_barrier
    s_add_u32 s60, s45, 0
    s_and_b32 s60, s60, 3
    s_or_b32 s60, s60, 8
    s_lshl_b32 s61, s60, 7
    s_mul_i32 s62, s60, 393216
    s_add_u32 m0, s43, 81920
    s_nop 0
    buffer_load_dwordx4 v8, s[48:51], s61 offen offset:0 lds
    buffer_load_dwordx4 v9, s[48:51], s61 offen offset:1024 lds
    buffer_load_dwordx4 v10, s[48:51], s61 offen offset:2048 lds
    buffer_load_dwordx4 v11, s[48:51], s61 offen offset:3072 lds
    s_add_u32 m0, s44, 81920
    s_nop 0
    s_nop 0
    buffer_load_dwordx4 v12, s[64:67], s62 offen offset:0 lds
    buffer_load_dwordx4 v13, s[64:67], s62 offen offset:1024 lds
    buffer_load_dwordx4 v14, s[64:67], s62 offen offset:2048 lds
    buffer_load_dwordx4 v15, s[64:67], s62 offen offset:3072 lds
    s_add_u32 m0, s44, 86016
    s_nop 0
    buffer_load_dwordx4 v16, s[64:67], s62 offen offset:0 lds
    buffer_load_dwordx4 v17, s[64:67], s62 offen offset:1024 lds
    s_waitcnt vmcnt(10)
    s_barrier
    s_add_u32 s60, s45, 1
    s_and_b32 s60, s60, 3
    s_or_b32 s60, s60, 8
    s_lshl_b32 s61, s60, 7
    s_mul_i32 s62, s60, 393216
    s_add_u32 m0, s43, 0
    s_nop 0
    buffer_load_dwordx4 v8, s[48:51], s61 offen offset:0 lds
    buffer_load_dwordx4 v9, s[48:51], s61 offen offset:1024 lds
    buffer_load_dwordx4 v10, s[48:51], s61 offen offset:2048 lds
    buffer_load_dwordx4 v11, s[48:51], s61 offen offset:3072 lds
    s_add_u32 m0, s44, 0
    s_nop 0
    s_nop 0
    buffer_load_dwordx4 v12, s[64:67], s62 offen offset:0 lds
    buffer_load_dwordx4 v13, s[64:67], s62 offen offset:1024 lds
    buffer_load_dwordx4 v14, s[64:67], s62 offen offset:2048 lds
    buffer_load_dwordx4 v15, s[64:67], s62 offen offset:3072 lds
    s_add_u32 m0, s44, 4096
    s_nop 0
    buffer_load_dwordx4 v16, s[64:67], s62 offen offset:0 lds
    buffer_load_dwordx4 v17, s[64:67], s62 offen offset:1024 lds
    s_waitcnt vmcnt(10)
    s_barrier
    s_add_u32 s60, s45, 2
    s_and_b32 s60, s60, 3
    s_or_b32 s60, s60, 8
    s_lshl_b32 s61, s60, 7
    s_mul_i32 s62, s60, 393216
    s_add_u32 m0, s43, 40960
    s_nop 0
    buffer_load_dwordx4 v8, s[48:51], s61 offen offset:0 lds
    buffer_load_dwordx4 v9, s[48:51], s61 offen offset:1024 lds
    buffer_load_dwordx4 v10, s[48:51], s61 offen offset:2048 lds
    buffer_load_dwordx4 v11, s[48:51], s61 offen offset:3072 lds
    s_add_u32 m0, s44, 40960
    s_nop 0
    s_nop 0
    buffer_load_dwordx4 v12, s[64:67], s62 offen offset:0 lds
    buffer_load_dwordx4 v13, s[64:67], s62 offen offset:1024 lds
    buffer_load_dwordx4 v14, s[64:67], s62 offen offset:2048 lds
    buffer_load_dwordx4 v15, s[64:67], s62 offen offset:3072 lds
    s_add_u32 m0, s44, 45056
    s_nop 0
    buffer_load_dwordx4 v16, s[64:67], s62 offen offset:0 lds
    buffer_load_dwordx4 v17, s[64:67], s62 offen offset:1024 lds
    s_waitcnt vmcnt(10)
    s_barrier
    s_add_u32 s60, s45, 3
    s_and_b32 s60, s60, 3
    s_or_b32 s60, s60, 8
    s_lshl_b32 s61, s60, 7
    s_mul_i32 s62, s60, 393216
    s_add_u32 m0, s43, 81920
    s_nop 0
    buffer_load_dwordx4 v8, s[48:51], s61 offen offset:0 lds
    buffer_load_dwordx4 v9, s[48:51], s61 offen offset:1024 lds
    buffer_load_dwordx4 v10, s[48:51], s61 offen offset:2048 lds
    buffer_load_dwordx4 v11, s[48:51], s61 offen offset:3072 lds
    s_add_u32 m0, s44, 81920
    s_nop 0
    s_nop 0
    buffer_load_dwordx4 v12, s[64:67], s62 offen offset:0 lds
    buffer_load_dwordx4 v13, s[64:67], s62 offen offset:1024 lds
    buffer_load_dwordx4 v14, s[64:67], s62 offen offset:2048 lds
    buffer_load_dwordx4 v15, s[64:67], s62 offen offset:3072 lds
    s_add_u32 m0, s44, 86016
    s_nop 0
    buffer_load_dwordx4 v16, s[64:67], s62 offen offset:0 lds
    buffer_load_dwordx4 v17, s[64:67], s62 offen offset:1024 lds
    s_waitcnt vmcnt(10)
    s_barrier
    s_add_u32 s60, s45, 0
    s_and_b32 s60, s60, 3
    s_or_b32 s60, s60, 12
    s_lshl_b32 s61, s60, 7
    s_mul_i32 s62, s60, 393216
    s_add_u32 m0, s43, 0
    s_nop 0
    buffer_load_dwordx4 v8, s[48:51], s61 offen offset:0 lds
    buffer_load_dwordx4 v9, s[48:51], s61 offen offset:1024 lds
    buffer_load_dwordx4 v10, s[48:51], s61 offen offset:2048 lds
    buffer_load_dwordx4 v11, s[48:51], s61 offen offset:3072 lds
    s_add_u32 m0, s44, 0
    s_nop 0
    s_nop 0
    buffer_load_dwordx4 v12, s[64:67], s62 offen offset:0 lds
    buffer_load_dwordx4 v13, s[64:67], s62 offen offset:1024 lds
    buffer_load_dwordx4 v14, s[64:67], s62 offen offset:2048 lds
    buffer_load_dwordx4 v15, s[64:67], s62 offen offset:3072 lds
    s_add_u32 m0, s44, 4096
    s_nop 0
    buffer_load_dwordx4 v16, s[64:67], s62 offen offset:0 lds
    buffer_load_dwordx4 v17, s[64:67], s62 offen offset:1024 lds
    s_waitcnt vmcnt(10)
    s_barrier
    s_add_u32 s60, s45, 1
    s_and_b32 s60, s60, 3
    s_or_b32 s60, s60, 12
    s_lshl_b32 s61, s60, 7
    s_mul_i32 s62, s60, 393216
    s_add_u32 m0, s43, 40960
    s_nop 0
    buffer_load_dwordx4 v8, s[48:51], s61 offen offset:0 lds
    buffer_load_dwordx4 v9, s[48:51], s61 offen offset:1024 lds
    buffer_load_dwordx4 v10, s[48:51], s61 offen offset:2048 lds
    buffer_load_dwordx4 v11, s[48:51], s61 offen offset:3072 lds
    s_add_u32 m0, s44, 40960
    s_nop 0
    s_nop 0
    buffer_load_dwordx4 v12, s[64:67], s62 offen offset:0 lds
    buffer_load_dwordx4 v13, s[64:67], s62 offen offset:1024 lds
    buffer_load_dwordx4 v14, s[64:67], s62 offen offset:2048 lds
    buffer_load_dwordx4 v15, s[64:67], s62 offen offset:3072 lds
    s_add_u32 m0, s44, 45056
    s_nop 0
    buffer_load_dwordx4 v16, s[64:67], s62 offen offset:0 lds
    buffer_load_dwordx4 v17, s[64:67], s62 offen offset:1024 lds
    s_waitcnt vmcnt(10)
    s_barrier
    s_add_u32 s60, s45, 2
    s_and_b32 s60, s60, 3
    s_or_b32 s60, s60, 12
    s_lshl_b32 s61, s60, 7
    s_mul_i32 s62, s60, 393216
    s_add_u32 m0, s43, 81920
    s_nop 0
    buffer_load_dwordx4 v8, s[48:51], s61 offen offset:0 lds
    buffer_load_dwordx4 v9, s[48:51], s61 offen offset:1024 lds
    buffer_load_dwordx4 v10, s[48:51], s61 offen offset:2048 lds
    buffer_load_dwordx4 v11, s[48:51], s61 offen offset:3072 lds
    s_add_u32 m0, s44, 81920
    s_nop 0
    s_nop 0
    buffer_load_dwordx4 v12, s[64:67], s62 offen offset:0 lds
    buffer_load_dwordx4 v13, s[64:67], s62 offen offset:1024 lds
    buffer_load_dwordx4 v14, s[64:67], s62 offen offset:2048 lds
    buffer_load_dwordx4 v15, s[64:67], s62 offen offset:3072 lds
    s_add_u32 m0, s44, 86016
    s_nop 0
    buffer_load_dwordx4 v16, s[64:67], s62 offen offset:0 lds
    buffer_load_dwordx4 v17, s[64:67], s62 offen offset:1024 lds
    s_waitcnt vmcnt(10)
    s_barrier
    s_add_u32 s60, s45, 3
    s_and_b32 s60, s60, 3
    s_or_b32 s60, s60, 12
    s_lshl_b32 s61, s60, 7
    s_mul_i32 s62, s60, 393216
    s_add_u32 m0, s43, 0
    s_nop 0
    buffer_load_dwordx4 v8, s[48:51], s61 offen offset:0 lds
    buffer_load_dwordx4 v9, s[48:51], s61 offen offset:1024 lds
    buffer_load_dwordx4 v10, s[48:51], s61 offen offset:2048 lds
    buffer_load_dwordx4 v11, s[48:51], s61 offen offset:3072 lds
    s_add_u32 m0, s44, 0
    s_nop 0
    s_nop 0
    buffer_load_dwordx4 v12, s[64:67], s62 offen offset:0 lds
    buffer_load_dwordx4 v13, s[64:67], s62 offen offset:1024 lds
    buffer_load_dwordx4 v14, s[64:67], s62 offen offset:2048 lds
    buffer_load_dwordx4 v15, s[64:67], s62 offen offset:3072 lds
    s_add_u32 m0, s44, 4096
    s_nop 0
    buffer_load_dwordx4 v16, s[64:67], s62 offen offset:0 lds
    buffer_load_dwordx4 v17, s[64:67], s62 offen offset:1024 lds
    s_setprio 2
    s_lshl_b32 s75, s47, 12
    s_add_u32 s76, s75, 0
    s_waitcnt vmcnt(10)
    s_barrier
    buffer_store_dwordx4 v[128:131], v26, s[56:59], s70 offen sc1
    s_add_u32 s70, s70, 65536
    buffer_store_dwordx4 v[132:135], v26, s[56:59], s70 offen sc1
    s_add_u32 s70, s70, 65536
    buffer_store_dwordx4 v[136:139], v26, s[56:59], s70 offen sc1
    s_add_u32 s70, s70, 65536
    buffer_store_dwordx4 v[140:143], v26, s[56:59], s70 offen sc1
    s_add_u32 s60, s97, 0
    s_and_b32 s60, s60, 15
    s_lshl_b32 s60, s60, 17
    s_add_u32 m0, s3, 122880
    s_nop 0
    buffer_load_dwordx4 v19, s[8:11], s60 offen offset:0 lds
    buffer_load_dwordx4 v20, s[8:11], s60 offen offset:1024 lds
    s_add_u32 s60, s97, 1
    s_and_b32 s60, s60, 15
    s_lshl_b32 s60, s60, 17
    s_add_u32 m0, s3, 131072
    s_nop 0
    buffer_load_dwordx4 v19, s[8:11], s60 offen offset:0 lds
    buffer_load_dwordx4 v20, s[8:11], s60 offen offset:1024 lds
    v_mov_b32 v1, 77728
    ds_write_b128 v1, v[28:31] offset:0
    ds_write_b128 v1, v[28:31] offset:16
    ds_write_b128 v1, v[28:31] offset:32
    ds_write_b128 v1, v[28:31] offset:48
    ds_write_b128 v1, v[28:31] offset:64
    s_waitcnt lgkmcnt(0)
    s_waitcnt vmcnt(8)
    s_barrier
    s_add_u32 s60, s97, 2
    s_and_b32 s60, s60, 15
    s_lshl_b32 s60, s60, 17
    s_add_u32 m0, s3, 139264
    s_nop 0
    buffer_load_dwordx4 v19, s[8:11], s60 offen offset:0 lds
    buffer_load_dwordx4 v20, s[8:11], s60 offen offset:1024 lds
    s_add_u32 s60, s97, 3
    s_and_b32 s60, s60, 15
    s_lshl_b32 s60, s60, 17
    s_add_u32 m0, s3, 147456
    s_nop 0
    buffer_load_dwordx4 v19, s[8:11], s60 offen offset:0 lds
    buffer_load_dwordx4 v20, s[8:11], s60 offen offset:1024 lds
    s_waitcnt vmcnt(8)
    v_mov_b32 v1, 77780
    v_mov_b32 v7, 1
    s_mov_b64 exec, 1
    ds_add_rtn_u32 v7, v1, v7
    s_mov_b64 exec, -1
    s_waitcnt lgkmcnt(0)
    v_readfirstlane_b32 s78, v7
    s_nop 1
    s_cmp_lg_u32 s78, 3
    s_cbranch_scc1 k_usig
    v_mov_b32 v40, s53
    v_mov_b32 v41, s53
    v_mov_b32 v42, s53
    v_mov_b32 v43, s53
    s_mov_b64 exec, 0xff
    buffer_store_dwordx4 v[40:43], v5, s[56:59], s23 offen sc1
    s_mov_b64 exec, -1
k_usig:
    s_waitcnt vmcnt(4)
    s_add_u32 s60, s97, 4
    s_and_b32 s60, s60, 15
    s_lshl_b32 s60, s60, 17
    s_add_u32 m0, s3, 155648
    s_nop 0
    buffer_load_dwordx4 v19, s[8:11], s60 offen offset:0 lds
    buffer_load_dwordx4 v20, s[8:11], s60 offen offset:1024 lds
    s_waitcnt vmcnt(4)
    s_add_u32 s60, s97, 5
    s_and_b32 s60, s60, 15
    s_lshl_b32 s60, s60, 17
    s_add_u32 m0, s3, 113664
    s_nop 0
    buffer_load_dwordx4 v19, s[8:11], s60 offen offset:0 lds
    buffer_load_dwordx4 v20, s[8:11], s60 offen offset:1024 lds
    s_waitcnt vmcnt(4)
    s_add_u32 s60, s97, 6
    s_and_b32 s60, s60, 15
    s_lshl_b32 s60, s60, 17
    buffer_load_dwordx4 v[144:147], v19, s[8:11], s60 offen offset:0
    buffer_load_dwordx4 v[148:151], v20, s[8:11], s60 offen offset:1024
    s_waitcnt vmcnt(4)
    s_add_u32 s60, s97, 7
    s_and_b32 s60, s60, 15
    s_lshl_b32 s60, s60, 17
    buffer_load_dwordx4 v[152:155], v19, s[8:11], s60 offen offset:0
    buffer_load_dwordx4 v[156:159], v20, s[8:11], s60 offen offset:1024
    s_waitcnt vmcnt(4)
    s_add_u32 s60, s97, 8
    s_and_b32 s60, s60, 15
    s_lshl_b32 s60, s60, 17
    buffer_load_dwordx4 v[160:163], v19, s[8:11], s60 offen offset:0
    buffer_load_dwordx4 v[164:167], v20, s[8:11], s60 offen offset:1024
    s_waitcnt vmcnt(4)
    s_add_u32 s60, s97, 9
    s_and_b32 s60, s60, 15
    s_lshl_b32 s60, s60, 17
    buffer_load_dwordx4 v[168:171], v19, s[8:11], s60 offen offset:0
    buffer_load_dwordx4 v[172:175], v20, s[8:11], s60 offen offset:1024
    s_waitcnt vmcnt(4)
    s_add_u32 s60, s97, 10
    s_and_b32 s60, s60, 15
    s_lshl_b32 s60, s60, 17
    buffer_load_dwordx4 v[176:179], v19, s[8:11], s60 offen offset:0
    buffer_load_dwordx4 v[180:183], v20, s[8:11], s60 offen offset:1024
    s_waitcnt vmcnt(4)
    s_add_u32 s60, s97, 11
    s_and_b32 s60, s60, 15
    s_lshl_b32 s60, s60, 17
    buffer_load_dwordx4 v[188:191], v19, s[8:11], s60 offen offset:0
    buffer_load_dwordx4 v[192:195], v20, s[8:11], s60 offen offset:1024
    s_waitcnt vmcnt(4)
    s_add_u32 s60, s97, 12
    s_and_b32 s60, s60, 15
    s_lshl_b32 s60, s60, 17
    buffer_load_dwordx4 v[196:199], v19, s[8:11], s60 offen offset:0
    buffer_load_dwordx4 v[200:203], v20, s[8:11], s60 offen offset:1024
    s_waitcnt vmcnt(4)
    s_add_u32 s60, s97, 13
    s_and_b32 s60, s60, 15
    s_lshl_b32 s60, s60, 17
    buffer_load_dwordx4 v[204:207], v19, s[8:11], s60 offen offset:0
    buffer_load_dwordx4 v[208:211], v20, s[8:11], s60 offen offset:1024
    s_waitcnt vmcnt(4)
    s_add_u32 s60, s97, 14
    s_and_b32 s60, s60, 15
    s_lshl_b32 s60, s60, 17
    buffer_load_dwordx4 v[212:215], v19, s[8:11], s60 offen offset:0
    buffer_load_dwordx4 v[216:219], v20, s[8:11], s60 offen offset:1024
    s_waitcnt vmcnt(4)
    s_add_u32 s60, s97, 15
    s_and_b32 s60, s60, 15
    s_lshl_b32 s60, s60, 17
    buffer_load_dwordx4 v[220:223], v19, s[8:11], s60 offen offset:0
    buffer_load_dwordx4 v[224:227], v20, s[8:11], s60 offen offset:1024
    ds_write_b128 v36, v[28:31]
    s_waitcnt lgkmcnt(0)
    v_mov_b32 v1, 77740
    s_mov_b32 s79, 1048576
k_ldone:
    ds_read_b32 v7, v1
    s_sub_u32 s79, s79, 1
    s_cbranch_scc1 k_ldone_x
    s_waitcnt lgkmcnt(0)
    v_readfirstlane_b32 s78, v7
    s_nop 1
    s_cmp_ge_u32 s78, 4
    s_cbranch_scc1 k_ldone_x
    s_branch k_ldone
k_ldone_x:
    s_waitcnt lgkmcnt(0)
    v_add_u32 v39, s3, v5
    ds_write_b128 v39, v[144:147] offset:0
    ds_write_b128 v39, v[148:151] offset:1024
    ds_write_b128 v39, v[152:155] offset:8192
    ds_write_b128 v39, v[156:159] offset:9216
    ds_write_b128 v39, v[160:163] offset:16384
    ds_write_b128 v39, v[164:167] offset:17408
    ds_write_b128 v39, v[168:171] offset:24576
    ds_write_b128 v39, v[172:175] offset:25600
    ds_write_b128 v39, v[176:179] offset:32768
    ds_write_b128 v39, v[180:183] offset:33792
    s_waitcnt vmcnt(0)
    v_mov_b32 v1, 77784
    v_mov_b32 v7, 1
    s_mov_b64 exec, 1
    ds_add_rtn_u32 v7, v1, v7
    s_mov_b64 exec, -1
    s_waitcnt lgkmcnt(0)
    v_readfirstlane_b32 s78, v7
    s_nop 1
    s_cmp_lg_u32 s78, 3
    s_cbranch_scc1 k_utpoll_w
    s_mov_b32 s79, 1048576
    s_branch k_utpoll
k_utpoll_again:
    s_sleep 8
k_utpoll:
    buffer_load_dword v44, v38, s[56:59], s22 offen sc1
    s_sub_u32 s79, s79, 1
    s_cbranch_scc1 k_utpoll_x
    s_waitcnt vmcnt(0)
    v_cmp_ne_u32 vcc, s53, v44
    s_cbranch_vccnz k_utpoll_again
k_utpoll_x:
    s_waitcnt vmcnt(0)
    v_mov_b32 v1, 77784
    v_mov_b32 v7, 1
    s_mov_b64 exec, 1
    ds_add_u32 v1, v7
    s_mov_b64 exec, -1
k_utpoll_w:
    v_mov_b32 v1, 77784
    s_mov_b32 s79, 1048576
k_utpoll_l:
    ds_read_b32 v7, v1
    s_sub_u32 s79, s79, 1
    s_cbranch_scc1 k_utpoll_l_x
    s_waitcnt lgkmcnt(0)
    v_readfirstlane_b32 s78, v7
    s_nop 1
    s_cmp_ge_u32 s78, 5
    s_cbranch_scc1 k_utpoll_l_x
    s_branch k_utpoll_l
k_utpoll_l_x:
    s_waitcnt lgkmcnt(0)
    s_waitcnt vmcnt(0)
    buffer_load_dwordx4 v[128:131], v5, s[56:59], s76 offen offset:0 sc1
    buffer_load_dwordx4 v[132:135], v5, s[56:59], s76 offen offset:1024 sc1
    buffer_load_dwordx4 v[136:139], v5, s[56:59], s76 offen offset:2048 sc1
    buffer_load_dwordx4 v[140:143], v5, s[56:59], s76 offen offset:3072 sc1
    s_waitcnt lgkmcnt(0)
    v_mov_b32 v1, 77744
    v_mov_b32 v7, 1
    s_mov_b64 exec, 1
    ds_add_u32 v1, v7
    s_mov_b64 exec, -1
    s_waitcnt vmcnt(0)
    ds_write_b128 v37, v[128:131] offset:480
    ds_write_b128 v37, v[132:135] offset:1504
    ds_write_b128 v37, v[136:139] offset:2528
    ds_write_b128 v37, v[140:143] offset:3552
    s_waitcnt lgkmcnt(0)
    v_mov_b32 v1, 77736
    s_mov_b32 s79, 1048576
k_hold:
    ds_read_b32 v7, v1
    s_sub_u32 s79, s79, 1
    s_cbranch_scc1 k_hold_x
    s_waitcnt lgkmcnt(0)
    v_readfirstlane_b32 s78, v7
    s_nop 1
    s_cmp_ge_u32 s78, 4
    s_cbranch_scc1 k_hold_x
    s_sleep 1
    s_branch k_hold
k_hold_x:
    s_waitcnt lgkmcnt(0)
    s_setprio 0
    v_lshlrev_b32 v234, 16, v234
    s_mov_b32 s78, 0x3fb8aa3b
    v_mul_f32 v248, s78, v234
    v_fma_f32 v249, v234, s78, -v248
    v_fmac_f32 v249, 0x32a57060, v234
    v_exp_f32 v248, v248
    v_mul_f32 v249, 0x3f317218, v249
    v_fma_f32 v248, v248, v249, v248
    v_cvt_pk_bf16_f32 v244, v248, v248
    v_lshlrev_b32 v244, 16, v244
    s_mov_b32 s46, 0
k_s_kgen:
    v_lshlrev_b32 v246, 16, v228
    v_mfma_f32_32x32x16_bf16 v[124:139], v[92:95], v[240:243], v[124:139]
    v_lshlrev_b32 v247, 16, v229
    v_lshlrev_b32 v62, 16, v230
    v_lshlrev_b32 v63, 16, v231
    v_lshlrev_b32 v64, 16, v232
    v_lshlrev_b32 v65, 16, v233
    v_mul_f32 v246, v246, v244
    v_mfma_f32_32x32x16_bf16 v[140:155], v[96:99], v[240:243], v[140:155]
    v_mul_f32 v247, v247, v244
    v_mul_f32 v246, 0x3fb8aa3b, v246
    v_mul_f32 v247, 0x3e22f983, v247
    v_exp_f32 v248, v246
    v_fract_f32 v249, v247
    v_cos_f32 v44, v249
    v_sin_f32 v45, v249
    v_mfma_f32_32x32x16_bf16 v[156:171], v[100:103], v[240:243], v[156:171]
    v_lshrrev_b32 v228, 16, v228
    v_lshrrev_b32 v229, 16, v229
    v_mul_f32 v44, v44, v248
    v_mul_f32 v45, v45, v248
    v_mul_f32 v248, 0x43800000, v246
    v_mul_f32 v249, 0x43800000, v247
    v_mfma_f32_32x32x16_bf16 v[172:187], v[104:107], v[240:243], v[172:187]
    v_exp_f32 v248, v248
    v_fract_f32 v249, v249
    v_cos_f32 v46, v249
    v_sin_f32 v47, v249
    v_lshrrev_b32 v230, 16, v230
    v_lshrrev_b32 v231, 16, v231
    v_mul_f32 v46, v46, v248
    v_mul_f32 v47, v47, v248
    v_lshrrev_b32 v232, 16, v232
    v_lshrrev_b32 v233, 16, v233
    s_cmp_eq_u32 s46, 0
    s_cbranch_scc1 k_s_kfirst
    s_nop 0
    v_cvt_pk_bf16_f32 v124, v124, v140
    v_cvt_pk_bf16_f32 v125, v125, v141
    v_cvt_pk_bf16_f32 v126, v126, v142
    v_cvt_pk_bf16_f32 v127, v127, v143
    v_cvt_pk_bf16_f32 v156, v156, v172
    v_cvt_pk_bf16_f32 v157, v157, v173
    v_cvt_pk_bf16_f32 v158, v158, v174
    v_cvt_pk_bf16_f32 v159, v159, v175
    v_cvt_pk_bf16_f32 v128, v128, v144
    v_cvt_pk_bf16_f32 v129, v129, v145
    v_mfma_f32_32x32x16_bf16 v[108:123], v[124:127], v[156:159], v[108:123]
    v_cvt_pk_bf16_f32 v130, v130, v146
    v_cvt_pk_bf16_f32 v131, v131, v147
    v_cvt_pk_bf16_f32 v160, v160, v176
    v_cvt_pk_bf16_f32 v161, v161, v177
    v_cvt_pk_bf16_f32 v162, v162, v178
    v_cvt_pk_bf16_f32 v163, v163, v179
    v_cvt_pk_bf16_f32 v132, v132, v148
    v_cvt_pk_bf16_f32 v133, v133, v149
    v_mfma_f32_32x32x16_bf16 v[108:123], v[128:131], v[160:163], v[108:123]
    v_cvt_pk_bf16_f32 v134, v134, v150
    v_cvt_pk_bf16_f32 v135, v135, v151
    v_cvt_pk_bf16_f32 v164, v164, v180
    v_cvt_pk_bf16_f32 v165, v165, v181
    v_cvt_pk_bf16_f32 v166, v166, v182
    v_cvt_pk_bf16_f32 v167, v167, v183
    v_cvt_pk_bf16_f32 v136, v136, v152
    v_cvt_pk_bf16_f32 v137, v137, v153
    v_mfma_f32_32x32x16_bf16 v[108:123], v[132:135], v[164:167], v[108:123]
    v_cvt_pk_bf16_f32 v138, v138, v154
    v_cvt_pk_bf16_f32 v139, v139, v155
    v_cvt_pk_bf16_f32 v168, v168, v184
    v_cvt_pk_bf16_f32 v169, v169, v185
    v_cvt_pk_bf16_f32 v170, v170, v186
    v_cvt_pk_bf16_f32 v171, v171, v187
    s_nop 1
    s_nop 0
    v_mfma_f32_32x32x16_bf16 v[108:123], v[136:139], v[168:171], v[108:123]
k_s_kfirst:
    v_pk_mul_f32 v[48:49], v[44:45], v[44:45] op_sel_hi:[1,0]
    v_pk_mul_f32 v[60:61], v[62:63], v[64:65] op_sel_hi:[1,0]
    v_pk_fma_f32 v[48:49], v[44:45], v[44:45], v[48:49] op_sel:[1,1,0] op_sel_hi:[0,1,1] neg_lo:[1,0,0]
    v_pk_fma_f32 v[60:61], v[62:63], v[64:65], v[60:61] op_sel:[1,1,0] op_sel_hi:[0,1,1] neg_lo:[1,0,0]
    v_pk_mul_f32 v[50:51], v[48:49], v[48:49] op_sel_hi:[1,0]
    v_mul_f32 v60, v60, v244
    v_pk_fma_f32 v[50:51], v[48:49], v[48:49], v[50:51] op_sel:[1,1,0] op_sel_hi:[0,1,1] neg_lo:[1,0,0]
    v_mul_f32 v61, v61, v244
    v_pk_mul_f32 v[52:53], v[50:51], v[50:51] op_sel_hi:[1,0]
    v_cndmask_b32 v58, 1.0, v50, s[72:73]
    v_pk_fma_f32 v[52:53], v[50:51], v[50:51], v[52:53] op_sel:[1,1,0] op_sel_hi:[0,1,1] neg_lo:[1,0,0]
    v_cndmask_b32 v59, 0, v51, s[72:73]
    v_pk_mul_f32 v[56:57], v[52:53], v[52:53] op_sel_hi:[1,0]
    v_pk_mul_f32 v[62:63], v[60:61], v[58:59] op_sel_hi:[1,0]
    v_pk_fma_f32 v[56:57], v[52:53], v[52:53], v[56:57] op_sel:[1,1,0] op_sel_hi:[0,1,1] neg_lo:[1,0,0]
    v_pk_fma_f32 v[62:63], v[60:61], v[58:59], v[62:63] op_sel:[1,1,0] op_sel_hi:[0,1,1] neg_lo:[1,0,0]
    v_pk_mul_f32 v[54:55], v[56:57], v[56:57] op_sel_hi:[1,0]
    v_pk_mul_f32 v[64:65], v[62:63], v[44:45] op_sel_hi:[1,0]
    v_pk_fma_f32 v[54:55], v[56:57], v[56:57], v[54:55] op_sel:[1,1,0] op_sel_hi:[0,1,1] neg_lo:[1,0,0]
    v_pk_fma_f32 v[64:65], v[62:63], v[44:45], v[64:65] op_sel:[1,1,0] op_sel_hi:[0,1,1] neg_lo:[1,0,0]
    v_pk_mul_f32 v[56:57], v[54:55], v[52:53] op_sel_hi:[1,0]
    v_pk_mul_f32 v[66:67], v[64:65], v[44:45] op_sel_hi:[1,0]
    v_pk_fma_f32 v[56:57], v[54:55], v[52:53], v[56:57] op_sel:[1,1,0] op_sel_hi:[0,1,1] neg_lo:[1,0,0]
    v_pk_fma_f32 v[66:67], v[64:65], v[44:45], v[66:67] op_sel:[1,1,0] op_sel_hi:[0,1,1] neg_lo:[1,0,0]
    v_cndmask_b32 v72, 1.0, v54, s[72:73]
    v_cndmask_b32 v73, 0, v55, s[72:73]
    v_cvt_pk_bf16_f32 v76, v62, v64
    v_cvt_pk_bf16_f32 v80, -v63, -v65
    v_pk_mul_f32 v[74:75], v[72:73], v[52:53] op_sel_hi:[1,0]
    s_nop 0
    v_pk_fma_f32 v[74:75], v[72:73], v[52:53], v[74:75] op_sel:[1,1,0] op_sel_hi:[0,1,1] neg_lo:[1,0,0]
    s_nop 0
    v_cvt_pk_bf16_f32 v84, v72, v74
    v_cvt_pk_bf16_f32 v88, v73, v75
    v_pk_mul_f32 v[72:73], v[74:75], v[52:53] op_sel_hi:[1,0]
    s_nop 0
    s_nop 0
    v_pk_fma_f32 v[72:73], v[74:75], v[52:53], v[72:73] op_sel:[1,1,0] op_sel_hi:[0,1,1] neg_lo:[1,0,0]
    v_pk_mul_f32 v[68:69], v[66:67], v[44:45] op_sel_hi:[1,0]
    v_pk_mul_f32 v[74:75], v[72:73], v[52:53] op_sel_hi:[1,0]
    v_pk_fma_f32 v[68:69], v[66:67], v[44:45], v[68:69] op_sel:[1,1,0] op_sel_hi:[0,1,1] neg_lo:[1,0,0]
    v_pk_fma_f32 v[74:75], v[72:73], v[52:53], v[74:75] op_sel:[1,1,0] op_sel_hi:[0,1,1] neg_lo:[1,0,0]
    v_cvt_pk_bf16_f32 v77, v66, v68
    v_cvt_pk_bf16_f32 v81, -v67, -v69
    v_cvt_pk_bf16_f32 v85, v72, v74
    v_cvt_pk_bf16_f32 v89, v73, v75
    v_pk_mul_f32 v[64:65], v[62:63], v[46:47] op_sel_hi:[1,0]
    v_pk_mul_f32 v[72:73], v[74:75], v[56:57] op_sel_hi:[1,0]
    v_pk_fma_f32 v[64:65], v[62:63], v[46:47], v[64:65] op_sel:[1,1,0] op_sel_hi:[0,1,1] neg_lo:[1,0,0]
    v_pk_fma_f32 v[72:73], v[74:75], v[56:57], v[72:73] op_sel:[1,1,0] op_sel_hi:[0,1,1] neg_lo:[1,0,0]
    v_pk_mul_f32 v[66:67], v[64:65], v[48:49] op_sel_hi:[1,0]
    v_pk_mul_f32 v[74:75], v[72:73], v[52:53] op_sel_hi:[1,0]
    v_pk_fma_f32 v[66:67], v[64:65], v[48:49], v[66:67] op_sel:[1,1,0] op_sel_hi:[0,1,1] neg_lo:[1,0,0]
    v_pk_fma_f32 v[74:75], v[72:73], v[52:53], v[74:75] op_sel:[1,1,0] op_sel_hi:[0,1,1] neg_lo:[1,0,0]
    v_cvt_pk_bf16_f32 v78, v64, v66
    v_cvt_pk_bf16_f32 v82, -v65, -v67
    v_cvt_pk_bf16_f32 v86, v72, v74
    v_cvt_pk_bf16_f32 v90, v73, v75
    v_pk_mul_f32 v[68:69], v[66:67], v[48:49] op_sel_hi:[1,0]
    v_pk_mul_f32 v[72:73], v[74:75], v[52:53] op_sel_hi:[1,0]
    v_pk_fma_f32 v[68:69], v[66:67], v[48:49], v[68:69] op_sel:[1,1,0] op_sel_hi:[0,1,1] neg_lo:[1,0,0]
    v_pk_fma_f32 v[72:73], v[74:75], v[52:53], v[72:73] op_sel:[1,1,0] op_sel_hi:[0,1,1] neg_lo:[1,0,0]
    v_pk_mul_f32 v[70:71], v[46:47], v[58:59] op_sel_hi:[1,0]
    v_pk_mul_f32 v[74:75], v[72:73], v[52:53] op_sel_hi:[1,0]
    v_pk_fma_f32 v[70:71], v[46:47], v[58:59], v[70:71] op_sel:[1,1,0] op_sel_hi:[0,1,1] neg_lo:[1,0,0]
    v_pk_fma_f32 v[74:75], v[72:73], v[52:53], v[74:75] op_sel:[1,1,0] op_sel_hi:[0,1,1] neg_lo:[1,0,0]
    v_cvt_pk_bf16_f32 v79, v68, v68
    v_cvt_pk_bf16_f32 v83, -v69, -v69
    v_cvt_pk_bf16_f32 v87, v72, v74
    v_cvt_pk_bf16_f32 v91, v73, v75
    v_pk_mul_f32 v[62:63], v[64:65], v[46:47] op_sel_hi:[1,0]
    v_pk_mul_f32 v[72:73], v[74:75], v[56:57] op_sel_hi:[1,0]
    v_pk_fma_f32 v[62:63], v[64:65], v[46:47], v[62:63] op_sel:[1,1,0] op_sel_hi:[0,1,1] neg_lo:[1,0,0]
    v_pk_fma_f32 v[72:73], v[74:75], v[56:57], v[72:73] op_sel:[1,1,0] op_sel_hi:[0,1,1] neg_lo:[1,0,0]
    v_pk_mul_f32 v[66:67], v[62:63], v[50:51] op_sel_hi:[1,0]
    v_pk_mul_f32 v[74:75], v[72:73], v[52:53] op_sel_hi:[1,0]
    v_pk_fma_f32 v[66:67], v[62:63], v[50:51], v[66:67] op_sel:[1,1,0] op_sel_hi:[0,1,1] neg_lo:[1,0,0]
    v_pk_fma_f32 v[74:75], v[72:73], v[52:53], v[74:75] op_sel:[1,1,0] op_sel_hi:[0,1,1] neg_lo:[1,0,0]
    v_mfma_f32_32x32x16_bf16 v[124:139], v[76:79], v[236:239], 0
    v_cvt_pk_bf16_f32 v92, v62, v66
    v_cvt_pk_bf16_f32 v96, -v63, -v67
    v_cvt_pk_bf16_f32 v100, v72, v74
    v_cvt_pk_bf16_f32 v104, v73, v75
    v_pk_mul_f32 v[64:65], v[62:63], v[46:47] op_sel_hi:[1,0]
    v_pk_mul_f32 v[72:73], v[74:75], v[52:53] op_sel_hi:[1,0]
    v_pk_fma_f32 v[64:65], v[62:63], v[46:47], v[64:65] op_sel:[1,1,0] op_sel_hi:[0,1,1] neg_lo:[1,0,0]
    v_pk_fma_f32 v[72:73], v[74:75], v[52:53], v[72:73] op_sel:[1,1,0] op_sel_hi:[0,1,1] neg_lo:[1,0,0]
    v_pk_mul_f32 v[68:69], v[64:65], v[50:51] op_sel_hi:[1,0]
    v_pk_mul_f32 v[74:75], v[72:73], v[52:53] op_sel_hi:[1,0]
    v_pk_fma_f32 v[68:69], v[64:65], v[50:51], v[68:69] op_sel:[1,1,0] op_sel_hi:[0,1,1] neg_lo:[1,0,0]
    v_pk_fma_f32 v[74:75], v[72:73], v[52:53], v[74:75] op_sel:[1,1,0] op_sel_hi:[0,1,1] neg_lo:[1,0,0]
    v_mfma_f32_32x32x16_bf16 v[140:155], v[80:83], v[236:239], 0
    v_cvt_pk_bf16_f32 v93, v64, v68
    v_cvt_pk_bf16_f32 v97, -v65, -v69
    v_cvt_pk_bf16_f32 v101, v72, v74
    v_cvt_pk_bf16_f32 v105, v73, v75
    v_pk_mul_f32 v[62:63], v[64:65], v[70:71] op_sel_hi:[1,0]
    v_pk_mul_f32 v[72:73], v[74:75], v[56:57] op_sel_hi:[1,0]
    v_pk_fma_f32 v[62:63], v[64:65], v[70:71], v[62:63] op_sel:[1,1,0] op_sel_hi:[0,1,1] neg_lo:[1,0,0]
    v_pk_fma_f32 v[72:73], v[74:75], v[56:57], v[72:73] op_sel:[1,1,0] op_sel_hi:[0,1,1] neg_lo:[1,0,0]
    v_pk_mul_f32 v[66:67], v[62:63], v[46:47] op_sel_hi:[1,0]
    v_pk_mul_f32 v[74:75], v[72:73], v[52:53] op_sel_hi:[1,0]
    v_pk_fma_f32 v[66:67], v[62:63], v[46:47], v[66:67] op_sel:[1,1,0] op_sel_hi:[0,1,1] neg_lo:[1,0,0]
    v_pk_fma_f32 v[74:75], v[72:73], v[52:53], v[74:75] op_sel:[1,1,0] op_sel_hi:[0,1,1] neg_lo:[1,0,0]
    v_mfma_f32_32x32x16_bf16 v[156:171], v[84:87], v[236:239], 0
    v_cvt_pk_bf16_f32 v94, v62, v66
    v_cvt_pk_bf16_f32 v98, -v63, -v67
    v_cvt_pk_bf16_f32 v102, v72, v74
    v_cvt_pk_bf16_f32 v106, v73, v75
    v_pk_mul_f32 v[64:65], v[66:67], v[46:47] op_sel_hi:[1,0]
    v_pk_mul_f32 v[72:73], v[74:75], v[52:53] op_sel_hi:[1,0]
    v_pk_fma_f32 v[64:65], v[66:67], v[46:47], v[64:65] op_sel:[1,1,0] op_sel_hi:[0,1,1] neg_lo:[1,0,0]
    v_pk_fma_f32 v[72:73], v[74:75], v[52:53], v[72:73] op_sel:[1,1,0] op_sel_hi:[0,1,1] neg_lo:[1,0,0]
    v_pk_mul_f32 v[68:69], v[64:65], v[46:47] op_sel_hi:[1,0]
    v_pk_mul_f32 v[74:75], v[72:73], v[52:53] op_sel_hi:[1,0]
    v_pk_fma_f32 v[68:69], v[64:65], v[46:47], v[68:69] op_sel:[1,1,0] op_sel_hi:[0,1,1] neg_lo:[1,0,0]
    v_pk_fma_f32 v[74:75], v[72:73], v[52:53], v[74:75] op_sel:[1,1,0] op_sel_hi:[0,1,1] neg_lo:[1,0,0]
    v_mfma_f32_32x32x16_bf16 v[172:187], v[88:91], v[236:239], 0
    v_cvt_pk_bf16_f32 v95, v64, v68
    v_cvt_pk_bf16_f32 v99, -v65, -v69
    v_cvt_pk_bf16_f32 v103, v72, v74
    v_cvt_pk_bf16_f32 v107, v73, v75
    s_add_u32 s46, s46, 1
    s_cmp_lt_u32 s46, 2
    s_cbranch_scc1 k_s_kgen
    v_mfma_f32_32x32x16_bf16 v[124:139], v[92:95], v[240:243], v[124:139]
    v_mfma_f32_32x32x16_bf16 v[140:155], v[96:99], v[240:243], v[140:155]
    v_mfma_f32_32x32x16_bf16 v[156:171], v[100:103], v[240:243], v[156:171]
    v_mfma_f32_32x32x16_bf16 v[172:187], v[104:107], v[240:243], v[172:187]
    s_nop 9
    v_cvt_pk_bf16_f32 v124, v124, v140
    v_cvt_pk_bf16_f32 v125, v125, v141
    v_cvt_pk_bf16_f32 v126, v126, v142
    v_cvt_pk_bf16_f32 v127, v127, v143
    v_cvt_pk_bf16_f32 v156, v156, v172
    v_cvt_pk_bf16_f32 v157, v157, v173
    v_cvt_pk_bf16_f32 v158, v158, v174
    v_cvt_pk_bf16_f32 v159, v159, v175
    v_cvt_pk_bf16_f32 v128, v128, v144
    v_cvt_pk_bf16_f32 v129, v129, v145
    v_mfma_f32_32x32x16_bf16 v[108:123], v[124:127], v[156:159], v[108:123]
    v_cvt_pk_bf16_f32 v130, v130, v146
    v_cvt_pk_bf16_f32 v131, v131, v147
    v_cvt_pk_bf16_f32 v160, v160, v176
    v_cvt_pk_bf16_f32 v161, v161, v177
    v_cvt_pk_bf16_f32 v162, v162, v178
    v_cvt_pk_bf16_f32 v163, v163, v179
    v_cvt_pk_bf16_f32 v132, v132, v148
    v_cvt_pk_bf16_f32 v133, v133, v149
    v_mfma_f32_32x32x16_bf16 v[108:123], v[128:131], v[160:163], v[108:123]
    v_cvt_pk_bf16_f32 v134, v134, v150
    v_cvt_pk_bf16_f32 v135, v135, v151
    v_cvt_pk_bf16_f32 v164, v164, v180
    v_cvt_pk_bf16_f32 v165, v165, v181
    v_cvt_pk_bf16_f32 v166, v166, v182
    v_cvt_pk_bf16_f32 v167, v167, v183
    v_cvt_pk_bf16_f32 v136, v136, v152
    v_cvt_pk_bf16_f32 v137, v137, v153
    v_mfma_f32_32x32x16_bf16 v[108:123], v[132:135], v[164:167], v[108:123]
    v_cvt_pk_bf16_f32 v138, v138, v154
    v_cvt_pk_bf16_f32 v139, v139, v155
    v_cvt_pk_bf16_f32 v168, v168, v184
    v_cvt_pk_bf16_f32 v169, v169, v185
    v_cvt_pk_bf16_f32 v170, v170, v186
    v_cvt_pk_bf16_f32 v171, v171, v187
    s_nop 1
    v_mfma_f32_32x32x16_bf16 v[108:123], v[136:139], v[168:171], v[108:123]
    v_add_u32 v4, 31, v0
    v_subrev_u32 v2, 32, v0
    v_cndmask_b32 v4, v4, v2, s[72:73]
    v_lshlrev_b32 v4, 2, v4
    s_nop 7
    ds_bpermute_b32 v44, v4, v111
    v_add_f32 v108, v108, v22
    v_readlane_b32 s78, v111, 63
    v_lshl_add_u32 v2, v18, 5, s74
    v_lshl_add_u32 v4, v3, 4, v2
    v_lshl_add_u32 v2, v3, 10, v2
    v_and_b32 v1, 15, v0
    v_lshl_add_u32 v1, v1, 2, s74
    v_mov_b32 v45, 0
    ds_write_b32 v1, v45
    v_cmp_eq_u32 vcc, 0, v0
    v_and_b32 v1, 1, v0
    v_cmp_eq_u32 s[70:71], 1, v1
    v_mov_b32 v46, s78
    v_cndmask_b32 v46, v112, v46, vcc
    v_cvt_pk_bf16_f32 v48, v112, v46
    v_cvt_pk_bf16_f32 v49, v112, v112
    v_cvt_pk_bf16_f32 v50, v113, v112
    v_cvt_pk_bf16_f32 v51, v114, v113
    ds_write_b128 v4, v[48:51] offset:1088
    v_cvt_pk_bf16_f32 v52, v116, v116
    v_cvt_pk_bf16_f32 v55, v117, v116
    v_cvt_pk_bf16_f32 v47, v117, v117
    v_mov_b32_e64 v53, v52
    v_cndmask_b32 v54, v52, v55, s[72:73]
    v_cndmask_b32 v55, v55, v47, s[72:73]
    ds_write_b128 v4, v[52:55] offset:2112
    v_cvt_pk_bf16_f32 v56, v118, v118
    v_cvt_pk_bf16_f32 v59, v119, v118
    v_cvt_pk_bf16_f32 v47, v119, v119
    v_mov_b32 v57, v56
    v_cndmask_b32 v58, v56, v59, s[72:73]
    v_cndmask_b32 v59, v59, v47, s[72:73]
    ds_write_b128 v4, v[56:59] offset:3136
    v_permlane32_swap_b32 v120, v121
    v_cvt_pk_bf16_f32 v60, v120, v120
    v_cvt_pk_bf16_f32 v47, v121, v120
    v_cvt_pk_bf16_f32 v66, v121, v121
    v_mov_b32 v61, v60
    v_mov_b32 v62, v60
    v_mov_b32 v63, v60
    v_mov_b32 v67, v66
    v_cndmask_b32 v64, v60, v47, s[70:71]
    v_cndmask_b32 v65, v47, v66, s[70:71]
    ds_write_b128 v2, v[60:63] offset:4160
    ds_write_b128 v2, v[64:67] offset:4176
    v_permlane32_swap_b32 v122, v123
    v_cvt_pk_bf16_f32 v68, v122, v122
    v_cvt_pk_bf16_f32 v47, v123, v122
    v_cvt_pk_bf16_f32 v74, v123, v123
    v_mov_b32 v69, v68
    v_mov_b32 v70, v68
    v_mov_b32 v71, v68
    v_mov_b32 v75, v74
    v_cndmask_b32 v72, v68, v47, s[70:71]
    v_cndmask_b32 v73, v47, v74, s[70:71]
    ds_write_b128 v2, v[68:71] offset:6208
    ds_write_b128 v2, v[72:75] offset:6224
    s_waitcnt lgkmcnt(8)
    v_cndmask_b32 v44, v44, v45, vcc
    s_nop 0
    v_cvt_pk_bf16_f32 v76, v108, v44
    v_cvt_pk_bf16_f32 v77, v109, v108
    v_cvt_pk_bf16_f32 v78, v110, v109
    v_cvt_pk_bf16_f32 v79, v111, v110
    ds_write_b128 v4, v[76:79] offset:64
    v_and_b32 v17, 15, v0
    v_lshrrev_b32 v2, 4, v0
    v_lshlrev_b32 v4, 3, v2
    v_sub_u32 v4, v17, v4
    v_add_u32_e64 v4, 26, v4
    v_lshl_add_u32 v8, v4, 2, s74
    v_add_u32 v9, 1024, v8
    v_add_u32 v10, 2048, v8
    v_add_u32 v11, 3072, v8
    v_add_u32 v12, 4096, v8
    v_add_u32 v13, 5120, v8
    v_add_u32 v14, 6144, v8
    v_add_u32 v15, 7168, v8
    v_lshlrev_b32 v4, 5, v17
    v_lshl_add_u32 v4, v2, 4, v4
    v_add_u32 v16, s63, v4
    s_waitcnt lgkmcnt(0)
    s_nop 0
    ds_read_b128 v[88:91], v16 offset:448
    ds_read2_b32 v[56:57], v8 offset0:6 offset1:4
    ds_read2_b32 v[58:59], v8 offset0:2 offset1:0
    ds_read_b128 v[92:95], v16 offset:960
    ds_read2_b32 v[60:61], v9 offset0:6 offset1:4
    ds_read2_b32 v[62:63], v9 offset0:2 offset1:0
    ds_read_b128 v[96:99], v16 offset:1472
    ds_read2_b32 v[64:65], v10 offset0:6 offset1:4
    ds_read2_b32 v[66:67], v10 offset0:2 offset1:0
    ds_read_b128 v[100:103], v16 offset:1984
    ds_read2_b32 v[68:69], v11 offset0:6 offset1:4
    ds_read2_b32 v[70:71], v11 offset0:2 offset1:0
    ds_read_b128 v[104:107], v16 offset:2496
    ds_read2_b32 v[72:73], v12 offset0:6 offset1:4
    ds_read2_b32 v[74:75], v12 offset0:2 offset1:0
    ds_read_b128 v[108:111], v16 offset:3008
    ds_read2_b32 v[76:77], v13 offset0:6 offset1:4
    ds_read2_b32 v[78:79], v13 offset0:2 offset1:0
    ds_read_b128 v[112:115], v16 offset:3520
    ds_read2_b32 v[80:81], v14 offset0:6 offset1:4
    ds_read2_b32 v[82:83], v14 offset0:2 offset1:0
    ds_read_b128 v[116:119], v16 offset:4032
    ds_read2_b32 v[84:85], v15 offset0:6 offset1:4
    ds_read2_b32 v[86:87], v15 offset0:2 offset1:0
    s_waitcnt lgkmcnt(15)
    s_nop 0
    v_mfma_f32_16x16x32_bf16 v[24:27], v[56:59], v[88:91], 0
    v_mfma_f32_16x16x32_bf16 v[28:31], v[60:63], v[88:91], 0
    v_mfma_f32_16x16x32_bf16 v[32:35], v[60:63], v[92:95], 0
    v_mfma_f32_16x16x32_bf16 v[28:31], v[56:59], v[92:95], v[28:31]
    v_mfma_f32_16x16x32_bf16 v[32:35], v[64:67], v[88:91], v[32:35]
    v_mfma_f32_16x16x32_bf16 v[36:39], v[64:67], v[92:95], 0
    v_mfma_f32_16x16x32_bf16 v[40:43], v[64:67], v[96:99], 0
    v_mfma_f32_16x16x32_bf16 v[32:35], v[56:59], v[96:99], v[32:35]
    v_mfma_f32_16x16x32_bf16 v[36:39], v[60:63], v[96:99], v[36:39]
    ds_read_b128 v[152:155], v16 offset:384
    s_waitcnt lgkmcnt(13)
    s_nop 0
    v_mfma_f32_16x16x32_bf16 v[36:39], v[68:71], v[88:91], v[36:39]
    ds_read2_b32 v[120:121], v8 offset0:38 offset1:36
    v_mfma_f32_16x16x32_bf16 v[40:43], v[68:71], v[92:95], v[40:43]
    ds_read2_b32 v[122:123], v8 offset0:34 offset1:32
    v_mfma_f32_16x16x32_bf16 v[44:47], v[68:71], v[96:99], 0
    ds_read_b128 v[156:159], v16 offset:896
    v_mfma_f32_16x16x32_bf16 v[48:51], v[68:71], v[100:103], 0
    ds_read2_b32 v[124:125], v9 offset0:38 offset1:36
    v_mfma_f32_16x16x32_bf16 v[36:39], v[56:59], v[100:103], v[36:39]
    ds_read2_b32 v[126:127], v9 offset0:34 offset1:32
    v_mfma_f32_16x16x32_bf16 v[40:43], v[60:63], v[100:103], v[40:43]
    ds_read_b128 v[160:163], v16 offset:1408
    v_mfma_f32_16x16x32_bf16 v[44:47], v[64:67], v[100:103], v[44:47]
    ds_read2_b32 v[128:129], v10 offset0:38 offset1:36
    s_waitcnt lgkmcnt(15)
    s_nop 0
    v_mfma_f32_16x16x32_bf16 v[40:43], v[72:75], v[88:91], v[40:43]
    ds_read2_b32 v[130:131], v10 offset0:34 offset1:32
    v_mfma_f32_16x16x32_bf16 v[44:47], v[72:75], v[92:95], v[44:47]
    ds_read_b128 v[164:167], v16 offset:1920
    v_mfma_f32_16x16x32_bf16 v[48:51], v[72:75], v[96:99], v[48:51]
    ds_read2_b32 v[132:133], v11 offset0:38 offset1:36
    v_mfma_f32_16x16x32_bf16 v[52:55], v[72:75], v[100:103], 0
    ds_read2_b32 v[134:135], v11 offset0:34 offset1:32
    v_mfma_f32_16x16x32_bf16 v[40:43], v[56:59], v[104:107], v[40:43]
    ds_read_b128 v[168:171], v16 offset:2432
    v_mfma_f32_16x16x32_bf16 v[44:47], v[60:63], v[104:107], v[44:47]
    ds_read2_b32 v[136:137], v12 offset0:38 offset1:36
    v_mfma_f32_16x16x32_bf16 v[48:51], v[64:67], v[104:107], v[48:51]
    ds_read2_b32 v[138:139], v12 offset0:34 offset1:32
    v_mfma_f32_16x16x32_bf16 v[52:55], v[68:71], v[104:107], v[52:55]
    ds_read_b128 v[172:175], v16 offset:2944
    s_waitcnt lgkmcnt(15)
    s_nop 0
    v_mfma_f32_16x16x32_bf16 v[44:47], v[76:79], v[88:91], v[44:47]
    ds_read2_b32 v[140:141], v13 offset0:38 offset1:36
    v_mfma_f32_16x16x32_bf16 v[48:51], v[76:79], v[92:95], v[48:51]
    ds_read2_b32 v[142:143], v13 offset0:34 offset1:32
    v_mfma_f32_16x16x32_bf16 v[52:55], v[76:79], v[96:99], v[52:55]
    ds_read_b128 v[176:179], v16 offset:3456
    v_mfma_f32_16x16x32_bf16 v[44:47], v[56:59], v[108:111], v[44:47]
    ds_read2_b32 v[144:145], v14 offset0:38 offset1:36
    v_mfma_f32_16x16x32_bf16 v[48:51], v[60:63], v[108:111], v[48:51]
    ds_read2_b32 v[146:147], v14 offset0:34 offset1:32
    v_mfma_f32_16x16x32_bf16 v[52:55], v[64:67], v[108:111], v[52:55]
    ds_read_b128 v[180:183], v16 offset:3968
    v_mfma_f32_16x16x32_bf16 v[48:51], v[80:83], v[88:91], v[48:51]
    ds_read2_b32 v[148:149], v15 offset0:38 offset1:36
    v_mfma_f32_16x16x32_bf16 v[52:55], v[80:83], v[92:95], v[52:55]
    ds_read2_b32 v[150:151], v15 offset0:34 offset1:32
    v_mfma_f32_16x16x32_bf16 v[48:51], v[56:59], v[112:115], v[48:51]
    v_mfma_f32_16x16x32_bf16 v[52:55], v[60:63], v[112:115], v[52:55]
    v_mfma_f32_16x16x32_bf16 v[52:55], v[84:87], v[88:91], v[52:55]
    v_mfma_f32_16x16x32_bf16 v[52:55], v[56:59], v[116:119], v[52:55]
    s_waitcnt lgkmcnt(15)
    s_nop 0
    v_mfma_f32_16x16x32_bf16 v[24:27], v[120:123], v[152:155], v[24:27]
    v_mfma_f32_16x16x32_bf16 v[28:31], v[124:127], v[152:155], v[28:31]
    v_mfma_f32_16x16x32_bf16 v[32:35], v[124:127], v[156:159], v[32:35]
    v_mfma_f32_16x16x32_bf16 v[28:31], v[120:123], v[156:159], v[28:31]
    v_mfma_f32_16x16x32_bf16 v[32:35], v[128:131], v[152:155], v[32:35]
    v_mfma_f32_16x16x32_bf16 v[36:39], v[128:131], v[156:159], v[36:39]
    v_mfma_f32_16x16x32_bf16 v[40:43], v[128:131], v[160:163], v[40:43]
    v_mfma_f32_16x16x32_bf16 v[32:35], v[120:123], v[160:163], v[32:35]
    v_mfma_f32_16x16x32_bf16 v[36:39], v[124:127], v[160:163], v[36:39]
    ds_read_b128 v[88:91], v16 offset:320
    s_waitcnt lgkmcnt(13)
    s_nop 0
    v_mfma_f32_16x16x32_bf16 v[36:39], v[132:135], v[152:155], v[36:39]
    ds_read2_b32 v[56:57], v8 offset0:70 offset1:68
    v_mfma_f32_16x16x32_bf16 v[40:43], v[132:135], v[156:159], v[40:43]
    ds_read2_b32 v[58:59], v8 offset0:66 offset1:64
    v_mfma_f32_16x16x32_bf16 v[44:47], v[132:135], v[160:163], v[44:47]
    ds_read_b128 v[92:95], v16 offset:832
    v_mfma_f32_16x16x32_bf16 v[48:51], v[132:135], v[164:167], v[48:51]
    ds_read2_b32 v[60:61], v9 offset0:70 offset1:68
    v_mfma_f32_16x16x32_bf16 v[36:39], v[120:123], v[164:167], v[36:39]
    ds_read2_b32 v[62:63], v9 offset0:66 offset1:64
    v_mfma_f32_16x16x32_bf16 v[40:43], v[124:127], v[164:167], v[40:43]
    ds_read_b128 v[96:99], v16 offset:1344
    v_mfma_f32_16x16x32_bf16 v[44:47], v[128:131], v[164:167], v[44:47]
    ds_read2_b32 v[64:65], v10 offset0:70 offset1:68
    s_waitcnt lgkmcnt(15)
    s_nop 0
    v_mfma_f32_16x16x32_bf16 v[40:43], v[136:139], v[152:155], v[40:43]
    ds_read2_b32 v[66:67], v10 offset0:66 offset1:64
    v_mfma_f32_16x16x32_bf16 v[44:47], v[136:139], v[156:159], v[44:47]
    ds_read_b128 v[100:103], v16 offset:1856
    v_mfma_f32_16x16x32_bf16 v[48:51], v[136:139], v[160:163], v[48:51]
    ds_read2_b32 v[68:69], v11 offset0:70 offset1:68
    v_mfma_f32_16x16x32_bf16 v[52:55], v[136:139], v[164:167], v[52:55]
    ds_read2_b32 v[70:71], v11 offset0:66 offset1:64
    v_mfma_f32_16x16x32_bf16 v[40:43], v[120:123], v[168:171], v[40:43]
    ds_read_b128 v[104:107], v16 offset:2368
    v_mfma_f32_16x16x32_bf16 v[44:47], v[124:127], v[168:171], v[44:47]
    ds_read2_b32 v[72:73], v12 offset0:70 offset1:68
    v_mfma_f32_16x16x32_bf16 v[48:51], v[128:131], v[168:171], v[48:51]
    ds_read2_b32 v[74:75], v12 offset0:66 offset1:64
    v_mfma_f32_16x16x32_bf16 v[52:55], v[132:135], v[168:171], v[52:55]
    ds_read_b128 v[108:111], v16 offset:2880
    s_waitcnt lgkmcnt(15)
    s_nop 0
    v_mfma_f32_16x16x32_bf16 v[44:47], v[140:143], v[152:155], v[44:47]
    ds_read2_b32 v[76:77], v13 offset0:70 offset1:68
    v_mfma_f32_16x16x32_bf16 v[48:51], v[140:143], v[156:159], v[48:51]
    ds_read2_b32 v[78:79], v13 offset0:66 offset1:64
    v_mfma_f32_16x16x32_bf16 v[52:55], v[140:143], v[160:163], v[52:55]
    ds_read_b128 v[112:115], v16 offset:3392
    v_mfma_f32_16x16x32_bf16 v[44:47], v[120:123], v[172:175], v[44:47]
    ds_read2_b32 v[80:81], v14 offset0:70 offset1:68
    v_mfma_f32_16x16x32_bf16 v[48:51], v[124:127], v[172:175], v[48:51]
    ds_read2_b32 v[82:83], v14 offset0:66 offset1:64
    v_mfma_f32_16x16x32_bf16 v[52:55], v[128:131], v[172:175], v[52:55]
    ds_read_b128 v[116:119], v16 offset:3904
    v_mfma_f32_16x16x32_bf16 v[48:51], v[144:147], v[152:155], v[48:51]
    ds_read2_b32 v[84:85], v15 offset0:70 offset1:68
    v_mfma_f32_16x16x32_bf16 v[52:55], v[144:147], v[156:159], v[52:55]
    ds_read2_b32 v[86:87], v15 offset0:66 offset1:64
    v_mfma_f32_16x16x32_bf16 v[48:51], v[120:123], v[176:179], v[48:51]
    v_mfma_f32_16x16x32_bf16 v[52:55], v[124:127], v[176:179], v[52:55]
    v_mfma_f32_16x16x32_bf16 v[52:55], v[148:151], v[152:155], v[52:55]
    v_mfma_f32_16x16x32_bf16 v[52:55], v[120:123], v[180:183], v[52:55]
    s_waitcnt lgkmcnt(15)
    s_nop 0
    v_mfma_f32_16x16x32_bf16 v[24:27], v[56:59], v[88:91], v[24:27]
    v_mfma_f32_16x16x32_bf16 v[28:31], v[60:63], v[88:91], v[28:31]
    v_mfma_f32_16x16x32_bf16 v[32:35], v[60:63], v[92:95], v[32:35]
    v_mfma_f32_16x16x32_bf16 v[28:31], v[56:59], v[92:95], v[28:31]
    v_mfma_f32_16x16x32_bf16 v[32:35], v[64:67], v[88:91], v[32:35]
    v_mfma_f32_16x16x32_bf16 v[36:39], v[64:67], v[92:95], v[36:39]
    v_mfma_f32_16x16x32_bf16 v[40:43], v[64:67], v[96:99], v[40:43]
    v_mfma_f32_16x16x32_bf16 v[32:35], v[56:59], v[96:99], v[32:35]
    v_mfma_f32_16x16x32_bf16 v[36:39], v[60:63], v[96:99], v[36:39]
    ds_read_b128 v[152:155], v16 offset:256
    s_waitcnt lgkmcnt(13)
    s_nop 0
    v_mfma_f32_16x16x32_bf16 v[36:39], v[68:71], v[88:91], v[36:39]
    ds_read2_b32 v[120:121], v8 offset0:102 offset1:100
    v_mfma_f32_16x16x32_bf16 v[40:43], v[68:71], v[92:95], v[40:43]
    ds_read2_b32 v[122:123], v8 offset0:98 offset1:96
    v_mfma_f32_16x16x32_bf16 v[44:47], v[68:71], v[96:99], v[44:47]
    ds_read_b128 v[156:159], v16 offset:768
    v_mfma_f32_16x16x32_bf16 v[48:51], v[68:71], v[100:103], v[48:51]
    ds_read2_b32 v[124:125], v9 offset0:102 offset1:100
    v_mfma_f32_16x16x32_bf16 v[36:39], v[56:59], v[100:103], v[36:39]
    ds_read2_b32 v[126:127], v9 offset0:98 offset1:96
    v_mfma_f32_16x16x32_bf16 v[40:43], v[60:63], v[100:103], v[40:43]
    ds_read_b128 v[160:163], v16 offset:1280
    v_mfma_f32_16x16x32_bf16 v[44:47], v[64:67], v[100:103], v[44:47]
    ds_read2_b32 v[128:129], v10 offset0:102 offset1:100
    s_waitcnt lgkmcnt(15)
    s_nop 0
    v_mfma_f32_16x16x32_bf16 v[40:43], v[72:75], v[88:91], v[40:43]
    ds_read2_b32 v[130:131], v10 offset0:98 offset1:96
    v_mfma_f32_16x16x32_bf16 v[44:47], v[72:75], v[92:95], v[44:47]
    ds_read_b128 v[164:167], v16 offset:1792
    v_mfma_f32_16x16x32_bf16 v[48:51], v[72:75], v[96:99], v[48:51]
    ds_read2_b32 v[132:133], v11 offset0:102 offset1:100
    v_mfma_f32_16x16x32_bf16 v[52:55], v[72:75], v[100:103], v[52:55]
    ds_read2_b32 v[134:135], v11 offset0:98 offset1:96
    v_mfma_f32_16x16x32_bf16 v[40:43], v[56:59], v[104:107], v[40:43]
    ds_read_b128 v[168:171], v16 offset:2304
    v_mfma_f32_16x16x32_bf16 v[44:47], v[60:63], v[104:107], v[44:47]
    ds_read2_b32 v[136:137], v12 offset0:102 offset1:100
    v_mfma_f32_16x16x32_bf16 v[48:51], v[64:67], v[104:107], v[48:51]
    ds_read2_b32 v[138:139], v12 offset0:98 offset1:96
    v_mfma_f32_16x16x32_bf16 v[52:55], v[68:71], v[104:107], v[52:55]
    ds_read_b128 v[172:175], v16 offset:2816
    s_waitcnt lgkmcnt(15)
    s_nop 0
    v_mfma_f32_16x16x32_bf16 v[44:47], v[76:79], v[88:91], v[44:47]
    ds_read2_b32 v[140:141], v13 offset0:102 offset1:100
    v_mfma_f32_16x16x32_bf16 v[48:51], v[76:79], v[92:95], v[48:51]
    ds_read2_b32 v[142:143], v13 offset0:98 offset1:96
    v_mfma_f32_16x16x32_bf16 v[52:55], v[76:79], v[96:99], v[52:55]
    ds_read_b128 v[176:179], v16 offset:3328
    v_mfma_f32_16x16x32_bf16 v[44:47], v[56:59], v[108:111], v[44:47]
    ds_read2_b32 v[144:145], v14 offset0:102 offset1:100
    v_mfma_f32_16x16x32_bf16 v[48:51], v[60:63], v[108:111], v[48:51]
    ds_read2_b32 v[146:147], v14 offset0:98 offset1:96
    v_mfma_f32_16x16x32_bf16 v[52:55], v[64:67], v[108:111], v[52:55]
    ds_read_b128 v[180:183], v16 offset:3840
    v_mfma_f32_16x16x32_bf16 v[48:51], v[80:83], v[88:91], v[48:51]
    ds_read2_b32 v[148:149], v15 offset0:102 offset1:100
    v_mfma_f32_16x16x32_bf16 v[52:55], v[80:83], v[92:95], v[52:55]
    ds_read2_b32 v[150:151], v15 offset0:98 offset1:96
    v_mfma_f32_16x16x32_bf16 v[48:51], v[56:59], v[112:115], v[48:51]
    v_mfma_f32_16x16x32_bf16 v[52:55], v[60:63], v[112:115], v[52:55]
    v_mfma_f32_16x16x32_bf16 v[52:55], v[84:87], v[88:91], v[52:55]
    v_mfma_f32_16x16x32_bf16 v[52:55], v[56:59], v[116:119], v[52:55]
    s_waitcnt lgkmcnt(15)
    s_nop 0
    v_mfma_f32_16x16x32_bf16 v[24:27], v[120:123], v[152:155], v[24:27]
    v_mfma_f32_16x16x32_bf16 v[28:31], v[124:127], v[152:155], v[28:31]
    v_mfma_f32_16x16x32_bf16 v[32:35], v[124:127], v[156:159], v[32:35]
    v_mfma_f32_16x16x32_bf16 v[28:31], v[120:123], v[156:159], v[28:31]
    v_mfma_f32_16x16x32_bf16 v[32:35], v[128:131], v[152:155], v[32:35]
    v_mfma_f32_16x16x32_bf16 v[36:39], v[128:131], v[156:159], v[36:39]
    v_mfma_f32_16x16x32_bf16 v[40:43], v[128:131], v[160:163], v[40:43]
    v_mfma_f32_16x16x32_bf16 v[32:35], v[120:123], v[160:163], v[32:35]
    v_mfma_f32_16x16x32_bf16 v[36:39], v[124:127], v[160:163], v[36:39]
    ds_read_b128 v[88:91], v16 offset:192
    s_waitcnt lgkmcnt(13)
    s_nop 0
    v_mfma_f32_16x16x32_bf16 v[36:39], v[132:135], v[152:155], v[36:39]
    ds_read2_b32 v[56:57], v8 offset0:134 offset1:132
    v_mfma_f32_16x16x32_bf16 v[40:43], v[132:135], v[156:159], v[40:43]
    ds_read2_b32 v[58:59], v8 offset0:130 offset1:128
    v_mfma_f32_16x16x32_bf16 v[44:47], v[132:135], v[160:163], v[44:47]
    ds_read_b128 v[92:95], v16 offset:704
    v_mfma_f32_16x16x32_bf16 v[48:51], v[132:135], v[164:167], v[48:51]
    ds_read2_b32 v[60:61], v9 offset0:134 offset1:132
    v_mfma_f32_16x16x32_bf16 v[36:39], v[120:123], v[164:167], v[36:39]
    ds_read2_b32 v[62:63], v9 offset0:130 offset1:128
    v_mfma_f32_16x16x32_bf16 v[40:43], v[124:127], v[164:167], v[40:43]
    ds_read_b128 v[96:99], v16 offset:1216
    v_mfma_f32_16x16x32_bf16 v[44:47], v[128:131], v[164:167], v[44:47]
    ds_read2_b32 v[64:65], v10 offset0:134 offset1:132
    s_waitcnt lgkmcnt(15)
    s_nop 0
    v_mfma_f32_16x16x32_bf16 v[40:43], v[136:139], v[152:155], v[40:43]
    ds_read2_b32 v[66:67], v10 offset0:130 offset1:128
    v_mfma_f32_16x16x32_bf16 v[44:47], v[136:139], v[156:159], v[44:47]
    ds_read_b128 v[100:103], v16 offset:1728
    v_mfma_f32_16x16x32_bf16 v[48:51], v[136:139], v[160:163], v[48:51]
    ds_read2_b32 v[68:69], v11 offset0:134 offset1:132
    v_mfma_f32_16x16x32_bf16 v[52:55], v[136:139], v[164:167], v[52:55]
    ds_read2_b32 v[70:71], v11 offset0:130 offset1:128
    v_mfma_f32_16x16x32_bf16 v[40:43], v[120:123], v[168:171], v[40:43]
    ds_read_b128 v[104:107], v16 offset:2240
    v_mfma_f32_16x16x32_bf16 v[44:47], v[124:127], v[168:171], v[44:47]
    ds_read2_b32 v[72:73], v12 offset0:134 offset1:132
    v_mfma_f32_16x16x32_bf16 v[48:51], v[128:131], v[168:171], v[48:51]
    ds_read2_b32 v[74:75], v12 offset0:130 offset1:128
    v_mfma_f32_16x16x32_bf16 v[52:55], v[132:135], v[168:171], v[52:55]
    ds_read_b128 v[108:111], v16 offset:2752
    s_waitcnt lgkmcnt(15)
    s_nop 0
    v_mfma_f32_16x16x32_bf16 v[44:47], v[140:143], v[152:155], v[44:47]
    ds_read2_b32 v[76:77], v13 offset0:134 offset1:132
    v_mfma_f32_16x16x32_bf16 v[48:51], v[140:143], v[156:159], v[48:51]
    ds_read2_b32 v[78:79], v13 offset0:130 offset1:128
    v_mfma_f32_16x16x32_bf16 v[52:55], v[140:143], v[160:163], v[52:55]
    ds_read_b128 v[112:115], v16 offset:3264
    v_mfma_f32_16x16x32_bf16 v[44:47], v[120:123], v[172:175], v[44:47]
    ds_read2_b32 v[80:81], v14 offset0:134 offset1:132
    v_mfma_f32_16x16x32_bf16 v[48:51], v[124:127], v[172:175], v[48:51]
    ds_read2_b32 v[82:83], v14 offset0:130 offset1:128
    v_mfma_f32_16x16x32_bf16 v[52:55], v[128:131], v[172:175], v[52:55]
    ds_read_b128 v[116:119], v16 offset:3776
    v_mfma_f32_16x16x32_bf16 v[48:51], v[144:147], v[152:155], v[48:51]
    ds_read2_b32 v[84:85], v15 offset0:134 offset1:132
    v_mfma_f32_16x16x32_bf16 v[52:55], v[144:147], v[156:159], v[52:55]
    ds_read2_b32 v[86:87], v15 offset0:130 offset1:128
    v_mfma_f32_16x16x32_bf16 v[48:51], v[120:123], v[176:179], v[48:51]
    v_mfma_f32_16x16x32_bf16 v[52:55], v[124:127], v[176:179], v[52:55]
    v_mfma_f32_16x16x32_bf16 v[52:55], v[148:151], v[152:155], v[52:55]
    v_mfma_f32_16x16x32_bf16 v[52:55], v[120:123], v[180:183], v[52:55]
    s_waitcnt lgkmcnt(15)
    s_nop 0
    v_mfma_f32_16x16x32_bf16 v[24:27], v[56:59], v[88:91], v[24:27]
    v_mfma_f32_16x16x32_bf16 v[28:31], v[60:63], v[88:91], v[28:31]
    v_mfma_f32_16x16x32_bf16 v[32:35], v[60:63], v[92:95], v[32:35]
    v_mfma_f32_16x16x32_bf16 v[28:31], v[56:59], v[92:95], v[28:31]
    v_mfma_f32_16x16x32_bf16 v[32:35], v[64:67], v[88:91], v[32:35]
    v_mfma_f32_16x16x32_bf16 v[36:39], v[64:67], v[92:95], v[36:39]
    v_mfma_f32_16x16x32_bf16 v[40:43], v[64:67], v[96:99], v[40:43]
    v_mfma_f32_16x16x32_bf16 v[32:35], v[56:59], v[96:99], v[32:35]
    v_mfma_f32_16x16x32_bf16 v[36:39], v[60:63], v[96:99], v[36:39]
    ds_read_b128 v[152:155], v16 offset:128
    s_waitcnt lgkmcnt(13)
    s_nop 0
    v_mfma_f32_16x16x32_bf16 v[36:39], v[68:71], v[88:91], v[36:39]
    ds_read2_b32 v[120:121], v8 offset0:166 offset1:164
    v_mfma_f32_16x16x32_bf16 v[40:43], v[68:71], v[92:95], v[40:43]
    ds_read2_b32 v[122:123], v8 offset0:162 offset1:160
    v_mfma_f32_16x16x32_bf16 v[44:47], v[68:71], v[96:99], v[44:47]
    ds_read_b128 v[156:159], v16 offset:640
    v_mfma_f32_16x16x32_bf16 v[48:51], v[68:71], v[100:103], v[48:51]
    ds_read2_b32 v[124:125], v9 offset0:166 offset1:164
    v_mfma_f32_16x16x32_bf16 v[36:39], v[56:59], v[100:103], v[36:39]
    ds_read2_b32 v[126:127], v9 offset0:162 offset1:160
    v_mfma_f32_16x16x32_bf16 v[40:43], v[60:63], v[100:103], v[40:43]
    ds_read_b128 v[160:163], v16 offset:1152
    v_mfma_f32_16x16x32_bf16 v[44:47], v[64:67], v[100:103], v[44:47]
    ds_read2_b32 v[128:129], v10 offset0:166 offset1:164
    s_waitcnt lgkmcnt(15)
    s_nop 0
    v_mfma_f32_16x16x32_bf16 v[40:43], v[72:75], v[88:91], v[40:43]
    ds_read2_b32 v[130:131], v10 offset0:162 offset1:160
    v_mfma_f32_16x16x32_bf16 v[44:47], v[72:75], v[92:95], v[44:47]
    ds_read_b128 v[164:167], v16 offset:1664
    v_mfma_f32_16x16x32_bf16 v[48:51], v[72:75], v[96:99], v[48:51]
    ds_read2_b32 v[132:133], v11 offset0:166 offset1:164
    v_mfma_f32_16x16x32_bf16 v[52:55], v[72:75], v[100:103], v[52:55]
    ds_read2_b32 v[134:135], v11 offset0:162 offset1:160
    v_mfma_f32_16x16x32_bf16 v[40:43], v[56:59], v[104:107], v[40:43]
    ds_read_b128 v[168:171], v16 offset:2176
    v_mfma_f32_16x16x32_bf16 v[44:47], v[60:63], v[104:107], v[44:47]
    ds_read2_b32 v[136:137], v12 offset0:166 offset1:164
    v_mfma_f32_16x16x32_bf16 v[48:51], v[64:67], v[104:107], v[48:51]
    ds_read2_b32 v[138:139], v12 offset0:162 offset1:160
    v_mfma_f32_16x16x32_bf16 v[52:55], v[68:71], v[104:107], v[52:55]
    ds_read_b128 v[172:175], v16 offset:2688
    s_waitcnt lgkmcnt(15)
    s_nop 0
    v_mfma_f32_16x16x32_bf16 v[44:47], v[76:79], v[88:91], v[44:47]
    ds_read2_b32 v[140:141], v13 offset0:166 offset1:164
    v_mfma_f32_16x16x32_bf16 v[48:51], v[76:79], v[92:95], v[48:51]
    ds_read2_b32 v[142:143], v13 offset0:162 offset1:160
    v_mfma_f32_16x16x32_bf16 v[52:55], v[76:79], v[96:99], v[52:55]
    ds_read_b128 v[176:179], v16 offset:3200
    v_mfma_f32_16x16x32_bf16 v[44:47], v[56:59], v[108:111], v[44:47]
    ds_read2_b32 v[144:145], v14 offset0:166 offset1:164
    v_mfma_f32_16x16x32_bf16 v[48:51], v[60:63], v[108:111], v[48:51]
    ds_read2_b32 v[146:147], v14 offset0:162 offset1:160
    v_mfma_f32_16x16x32_bf16 v[52:55], v[64:67], v[108:111], v[52:55]
    ds_read_b128 v[180:183], v16 offset:3712
    v_mfma_f32_16x16x32_bf16 v[48:51], v[80:83], v[88:91], v[48:51]
    ds_read2_b32 v[148:149], v15 offset0:166 offset1:164
    v_mfma_f32_16x16x32_bf16 v[52:55], v[80:83], v[92:95], v[52:55]
    ds_read2_b32 v[150:151], v15 offset0:162 offset1:160
    v_mfma_f32_16x16x32_bf16 v[48:51], v[56:59], v[112:115], v[48:51]
    v_mfma_f32_16x16x32_bf16 v[52:55], v[60:63], v[112:115], v[52:55]
    v_mfma_f32_16x16x32_bf16 v[52:55], v[84:87], v[88:91], v[52:55]
    v_mfma_f32_16x16x32_bf16 v[52:55], v[56:59], v[116:119], v[52:55]
    s_waitcnt lgkmcnt(15)
    s_nop 0
    v_mfma_f32_16x16x32_bf16 v[24:27], v[120:123], v[152:155], v[24:27]
    v_mfma_f32_16x16x32_bf16 v[28:31], v[124:127], v[152:155], v[28:31]
    v_mfma_f32_16x16x32_bf16 v[32:35], v[124:127], v[156:159], v[32:35]
    v_mfma_f32_16x16x32_bf16 v[28:31], v[120:123], v[156:159], v[28:31]
    v_mfma_f32_16x16x32_bf16 v[32:35], v[128:131], v[152:155], v[32:35]
    v_mfma_f32_16x16x32_bf16 v[36:39], v[128:131], v[156:159], v[36:39]
    v_mfma_f32_16x16x32_bf16 v[40:43], v[128:131], v[160:163], v[40:43]
    v_mfma_f32_16x16x32_bf16 v[32:35], v[120:123], v[160:163], v[32:35]
    v_mfma_f32_16x16x32_bf16 v[36:39], v[124:127], v[160:163], v[36:39]
    ds_read_b128 v[88:91], v16 offset:64
    s_waitcnt lgkmcnt(13)
    s_nop 0
    v_mfma_f32_16x16x32_bf16 v[36:39], v[132:135], v[152:155], v[36:39]
    ds_read2_b32 v[56:57], v8 offset0:198 offset1:196
    v_mfma_f32_16x16x32_bf16 v[40:43], v[132:135], v[156:159], v[40:43]
    ds_read2_b32 v[58:59], v8 offset0:194 offset1:192
    v_mfma_f32_16x16x32_bf16 v[44:47], v[132:135], v[160:163], v[44:47]
    ds_read_b128 v[92:95], v16 offset:576
    v_mfma_f32_16x16x32_bf16 v[48:51], v[132:135], v[164:167], v[48:51]
    ds_read2_b32 v[60:61], v9 offset0:198 offset1:196
    v_mfma_f32_16x16x32_bf16 v[36:39], v[120:123], v[164:167], v[36:39]
    ds_read2_b32 v[62:63], v9 offset0:194 offset1:192
    v_mfma_f32_16x16x32_bf16 v[40:43], v[124:127], v[164:167], v[40:43]
    ds_read_b128 v[96:99], v16 offset:1088
    v_mfma_f32_16x16x32_bf16 v[44:47], v[128:131], v[164:167], v[44:47]
    ds_read2_b32 v[64:65], v10 offset0:198 offset1:196
    s_waitcnt lgkmcnt(15)
    s_nop 0
    v_mfma_f32_16x16x32_bf16 v[40:43], v[136:139], v[152:155], v[40:43]
    ds_read2_b32 v[66:67], v10 offset0:194 offset1:192
    v_mfma_f32_16x16x32_bf16 v[44:47], v[136:139], v[156:159], v[44:47]
    ds_read_b128 v[100:103], v16 offset:1600
    v_mfma_f32_16x16x32_bf16 v[48:51], v[136:139], v[160:163], v[48:51]
    ds_read2_b32 v[68:69], v11 offset0:198 offset1:196
    v_mfma_f32_16x16x32_bf16 v[52:55], v[136:139], v[164:167], v[52:55]
    ds_read2_b32 v[70:71], v11 offset0:194 offset1:192
    v_mfma_f32_16x16x32_bf16 v[40:43], v[120:123], v[168:171], v[40:43]
    ds_read_b128 v[104:107], v16 offset:2112
    v_mfma_f32_16x16x32_bf16 v[44:47], v[124:127], v[168:171], v[44:47]
    ds_read2_b32 v[72:73], v12 offset0:198 offset1:196
    v_mfma_f32_16x16x32_bf16 v[48:51], v[128:131], v[168:171], v[48:51]
    ds_read2_b32 v[74:75], v12 offset0:194 offset1:192
    v_mfma_f32_16x16x32_bf16 v[52:55], v[132:135], v[168:171], v[52:55]
    ds_read_b128 v[108:111], v16 offset:2624
    s_waitcnt lgkmcnt(15)
    s_nop 0
    v_mfma_f32_16x16x32_bf16 v[44:47], v[140:143], v[152:155], v[44:47]
    ds_read2_b32 v[76:77], v13 offset0:198 offset1:196
    v_mfma_f32_16x16x32_bf16 v[48:51], v[140:143], v[156:159], v[48:51]
    ds_read2_b32 v[78:79], v13 offset0:194 offset1:192
    v_mfma_f32_16x16x32_bf16 v[52:55], v[140:143], v[160:163], v[52:55]
    ds_read_b128 v[112:115], v16 offset:3136
    v_mfma_f32_16x16x32_bf16 v[44:47], v[120:123], v[172:175], v[44:47]
    ds_read2_b32 v[80:81], v14 offset0:198 offset1:196
    v_mfma_f32_16x16x32_bf16 v[48:51], v[124:127], v[172:175], v[48:51]
    ds_read2_b32 v[82:83], v14 offset0:194 offset1:192
    v_mfma_f32_16x16x32_bf16 v[52:55], v[128:131], v[172:175], v[52:55]
    ds_read_b128 v[116:119], v16 offset:3648
    v_mfma_f32_16x16x32_bf16 v[48:51], v[144:147], v[152:155], v[48:51]
    ds_read2_b32 v[84:85], v15 offset0:198 offset1:196
    v_mfma_f32_16x16x32_bf16 v[52:55], v[144:147], v[156:159], v[52:55]
    ds_read2_b32 v[86:87], v15 offset0:194 offset1:192
    v_mfma_f32_16x16x32_bf16 v[48:51], v[120:123], v[176:179], v[48:51]
    v_mfma_f32_16x16x32_bf16 v[52:55], v[124:127], v[176:179], v[52:55]
    v_mfma_f32_16x16x32_bf16 v[52:55], v[148:151], v[152:155], v[52:55]
    v_mfma_f32_16x16x32_bf16 v[52:55], v[120:123], v[180:183], v[52:55]
    s_waitcnt lgkmcnt(15)
    s_nop 0
    v_mfma_f32_16x16x32_bf16 v[24:27], v[56:59], v[88:91], v[24:27]
    v_mfma_f32_16x16x32_bf16 v[28:31], v[60:63], v[88:91], v[28:31]
    v_mfma_f32_16x16x32_bf16 v[32:35], v[60:63], v[92:95], v[32:35]
    v_mfma_f32_16x16x32_bf16 v[28:31], v[56:59], v[92:95], v[28:31]
    v_mfma_f32_16x16x32_bf16 v[32:35], v[64:67], v[88:91], v[32:35]
    v_mfma_f32_16x16x32_bf16 v[36:39], v[64:67], v[92:95], v[36:39]
    v_mfma_f32_16x16x32_bf16 v[40:43], v[64:67], v[96:99], v[40:43]
    v_mfma_f32_16x16x32_bf16 v[32:35], v[56:59], v[96:99], v[32:35]
    v_mfma_f32_16x16x32_bf16 v[36:39], v[60:63], v[96:99], v[36:39]
    ds_read_b128 v[152:155], v16 offset:0
    s_waitcnt lgkmcnt(13)
    s_nop 0
    v_mfma_f32_16x16x32_bf16 v[36:39], v[68:71], v[88:91], v[36:39]
    ds_read2_b32 v[120:121], v8 offset0:230 offset1:228
    v_mfma_f32_16x16x32_bf16 v[40:43], v[68:71], v[92:95], v[40:43]
    ds_read2_b32 v[122:123], v8 offset0:226 offset1:224
    v_mfma_f32_16x16x32_bf16 v[44:47], v[68:71], v[96:99], v[44:47]
    ds_read_b128 v[156:159], v16 offset:512
    v_mfma_f32_16x16x32_bf16 v[48:51], v[68:71], v[100:103], v[48:51]
    ds_read2_b32 v[124:125], v9 offset0:230 offset1:228
    v_mfma_f32_16x16x32_bf16 v[36:39], v[56:59], v[100:103], v[36:39]
    ds_read2_b32 v[126:127], v9 offset0:226 offset1:224
    v_mfma_f32_16x16x32_bf16 v[40:43], v[60:63], v[100:103], v[40:43]
    ds_read_b128 v[160:163], v16 offset:1024
    v_mfma_f32_16x16x32_bf16 v[44:47], v[64:67], v[100:103], v[44:47]
    ds_read2_b32 v[128:129], v10 offset0:230 offset1:228
    s_waitcnt lgkmcnt(15)
    s_nop 0
    v_mfma_f32_16x16x32_bf16 v[40:43], v[72:75], v[88:91], v[40:43]
    ds_read2_b32 v[130:131], v10 offset0:226 offset1:224
    v_mfma_f32_16x16x32_bf16 v[44:47], v[72:75], v[92:95], v[44:47]
    ds_read_b128 v[164:167], v16 offset:1536
    v_mfma_f32_16x16x32_bf16 v[48:51], v[72:75], v[96:99], v[48:51]
    ds_read2_b32 v[132:133], v11 offset0:230 offset1:228
    v_mfma_f32_16x16x32_bf16 v[52:55], v[72:75], v[100:103], v[52:55]
    ds_read2_b32 v[134:135], v11 offset0:226 offset1:224
    v_mfma_f32_16x16x32_bf16 v[40:43], v[56:59], v[104:107], v[40:43]
    ds_read_b128 v[168:171], v16 offset:2048
    v_mfma_f32_16x16x32_bf16 v[44:47], v[60:63], v[104:107], v[44:47]
    ds_read2_b32 v[136:137], v12 offset0:230 offset1:228
    v_mfma_f32_16x16x32_bf16 v[48:51], v[64:67], v[104:107], v[48:51]
    ds_read2_b32 v[138:139], v12 offset0:226 offset1:224
    v_mfma_f32_16x16x32_bf16 v[52:55], v[68:71], v[104:107], v[52:55]
    ds_read_b128 v[172:175], v16 offset:2560
    s_waitcnt lgkmcnt(15)
    s_nop 0
    v_mfma_f32_16x16x32_bf16 v[44:47], v[76:79], v[88:91], v[44:47]
    ds_read2_b32 v[140:141], v13 offset0:230 offset1:228
    v_mfma_f32_16x16x32_bf16 v[48:51], v[76:79], v[92:95], v[48:51]
    ds_read2_b32 v[142:143], v13 offset0:226 offset1:224
    v_mfma_f32_16x16x32_bf16 v[52:55], v[76:79], v[96:99], v[52:55]
    ds_read_b128 v[176:179], v16 offset:3072
    v_mfma_f32_16x16x32_bf16 v[44:47], v[56:59], v[108:111], v[44:47]
    ds_read2_b32 v[144:145], v14 offset0:230 offset1:228
    v_mfma_f32_16x16x32_bf16 v[48:51], v[60:63], v[108:111], v[48:51]
    ds_read2_b32 v[146:147], v14 offset0:226 offset1:224
    v_mfma_f32_16x16x32_bf16 v[52:55], v[64:67], v[108:111], v[52:55]
    ds_read_b128 v[180:183], v16 offset:3584
    v_mfma_f32_16x16x32_bf16 v[48:51], v[80:83], v[88:91], v[48:51]
    ds_read2_b32 v[148:149], v15 offset0:230 offset1:228
    v_mfma_f32_16x16x32_bf16 v[52:55], v[80:83], v[92:95], v[52:55]
    ds_read2_b32 v[150:151], v15 offset0:226 offset1:224
    v_mfma_f32_16x16x32_bf16 v[48:51], v[56:59], v[112:115], v[48:51]
    v_mfma_f32_16x16x32_bf16 v[52:55], v[60:63], v[112:115], v[52:55]
    v_mfma_f32_16x16x32_bf16 v[52:55], v[84:87], v[88:91], v[52:55]
    v_mfma_f32_16x16x32_bf16 v[52:55], v[56:59], v[116:119], v[52:55]
    s_waitcnt lgkmcnt(15)
    s_nop 0
    v_mfma_f32_16x16x32_bf16 v[24:27], v[120:123], v[152:155], v[24:27]
    v_mfma_f32_16x16x32_bf16 v[28:31], v[124:127], v[152:155], v[28:31]
    v_mfma_f32_16x16x32_bf16 v[32:35], v[124:127], v[156:159], v[32:35]
    v_mfma_f32_16x16x32_bf16 v[28:31], v[120:123], v[156:159], v[28:31]
    v_mfma_f32_16x16x32_bf16 v[32:35], v[128:131], v[152:155], v[32:35]
    v_mfma_f32_16x16x32_bf16 v[36:39], v[128:131], v[156:159], v[36:39]
    v_mfma_f32_16x16x32_bf16 v[40:43], v[128:131], v[160:163], v[40:43]
    v_mfma_f32_16x16x32_bf16 v[32:35], v[120:123], v[160:163], v[32:35]
    v_mfma_f32_16x16x32_bf16 v[36:39], v[124:127], v[160:163], v[36:39]
    s_waitcnt lgkmcnt(12)
    s_nop 0
    v_mfma_f32_16x16x32_bf16 v[36:39], v[132:135], v[152:155], v[36:39]
    v_mfma_f32_16x16x32_bf16 v[40:43], v[132:135], v[156:159], v[40:43]
    v_mfma_f32_16x16x32_bf16 v[44:47], v[132:135], v[160:163], v[44:47]
    v_mfma_f32_16x16x32_bf16 v[48:51], v[132:135], v[164:167], v[48:51]
    v_mfma_f32_16x16x32_bf16 v[36:39], v[120:123], v[164:167], v[36:39]
    v_mfma_f32_16x16x32_bf16 v[40:43], v[124:127], v[164:167], v[40:43]
    v_mfma_f32_16x16x32_bf16 v[44:47], v[128:131], v[164:167], v[44:47]
    s_waitcnt lgkmcnt(9)
    s_nop 0
    v_mfma_f32_16x16x32_bf16 v[40:43], v[136:139], v[152:155], v[40:43]
    v_mfma_f32_16x16x32_bf16 v[44:47], v[136:139], v[156:159], v[44:47]
    v_mfma_f32_16x16x32_bf16 v[48:51], v[136:139], v[160:163], v[48:51]
    v_mfma_f32_16x16x32_bf16 v[52:55], v[136:139], v[164:167], v[52:55]
    v_mfma_f32_16x16x32_bf16 v[40:43], v[120:123], v[168:171], v[40:43]
    v_mfma_f32_16x16x32_bf16 v[44:47], v[124:127], v[168:171], v[44:47]
    v_mfma_f32_16x16x32_bf16 v[48:51], v[128:131], v[168:171], v[48:51]
    v_mfma_f32_16x16x32_bf16 v[52:55], v[132:135], v[168:171], v[52:55]
    s_waitcnt lgkmcnt(6)
    s_nop 0
    v_mfma_f32_16x16x32_bf16 v[44:47], v[140:143], v[152:155], v[44:47]
    v_mfma_f32_16x16x32_bf16 v[48:51], v[140:143], v[156:159], v[48:51]
    v_mfma_f32_16x16x32_bf16 v[52:55], v[140:143], v[160:163], v[52:55]
    v_mfma_f32_16x16x32_bf16 v[44:47], v[120:123], v[172:175], v[44:47]
    v_mfma_f32_16x16x32_bf16 v[48:51], v[124:127], v[172:175], v[48:51]
    v_mfma_f32_16x16x32_bf16 v[52:55], v[128:131], v[172:175], v[52:55]
    s_waitcnt lgkmcnt(3)
    v_mfma_f32_16x16x32_bf16 v[48:51], v[144:147], v[152:155], v[48:51]
    v_mfma_f32_16x16x32_bf16 v[52:55], v[144:147], v[156:159], v[52:55]
    v_mfma_f32_16x16x32_bf16 v[48:51], v[120:123], v[176:179], v[48:51]
    v_mfma_f32_16x16x32_bf16 v[52:55], v[124:127], v[176:179], v[52:55]
    s_waitcnt lgkmcnt(0)
    v_mfma_f32_16x16x32_bf16 v[52:55], v[148:151], v[152:155], v[52:55]
    v_mfma_f32_16x16x32_bf16 v[52:55], v[120:123], v[180:183], v[52:55]
    s_setprio 2
    s_waitcnt lgkmcnt(0)
    v_mov_b32 v1, 77752
    v_mov_b32 v7, 1
    s_mov_b64 exec, 1
    ds_add_u32 v1, v7
    s_mov_b64 exec, -1
    v_and_b32 v4, 1, v2
    v_lshlrev_b32 v4, 9, v4
    v_lshl_add_u32 v4, v17, 5, v4
    v_lshrrev_b32 v2, 1, v2
    v_lshl_add_u32 v4, v2, 4, v4
    s_add_u32 s76, s75, 4194304
    v_cvt_pk_bf16_f32 v56, v24, v25
    v_cvt_pk_bf16_f32 v57, v26, v27
    v_cvt_pk_bf16_f32 v58, v28, v29
    v_cvt_pk_bf16_f32 v59, v30, v31
    v_cvt_pk_bf16_f32 v60, v32, v33
    v_cvt_pk_bf16_f32 v61, v34, v35
    v_cvt_pk_bf16_f32 v62, v36, v37
    v_cvt_pk_bf16_f32 v63, v38, v39
    v_cvt_pk_bf16_f32 v64, v40, v41
    v_cvt_pk_bf16_f32 v65, v42, v43
    v_cvt_pk_bf16_f32 v66, v44, v45
    v_cvt_pk_bf16_f32 v67, v46, v47
    v_cvt_pk_bf16_f32 v68, v48, v49
    v_cvt_pk_bf16_f32 v69, v50, v51
    v_cvt_pk_bf16_f32 v70, v52, v53
    v_cvt_pk_bf16_f32 v71, v54, v55
    v_permlane16_swap_b32 v56, v58
    v_permlane16_swap_b32 v57, v59
    v_permlane16_swap_b32 v60, v62
    v_permlane16_swap_b32 v61, v63
    v_permlane16_swap_b32 v64, v66
    v_permlane16_swap_b32 v65, v67
    v_permlane16_swap_b32 v68, v70
    v_permlane16_swap_b32 v69, v71
    v_add_u32 v2, s3, v5
    v_mov_b32 v1, 77752
    s_mov_b32 s79, 1048576
k_cdone:
    ds_read_b32 v7, v1
    s_sub_u32 s79, s79, 1
    s_cbranch_scc1 k_cdone_x
    s_waitcnt lgkmcnt(0)
    v_readfirstlane_b32 s78, v7
    s_nop 1
    s_cmp_ge_u32 s78, 4
    s_cbranch_scc1 k_cdone_x
    s_sleep 1
    s_branch k_cdone
k_cdone_x:
    s_waitcnt lgkmcnt(0)
    s_waitcnt vmcnt(0)
    ds_write_b128 v2, v[188:191] offset:40960
    ds_write_b128 v2, v[192:195] offset:41984
    ds_write_b128 v2, v[196:199] offset:49152
    ds_write_b128 v2, v[200:203] offset:50176
    ds_write_b128 v2, v[204:207] offset:57344
    ds_write_b128 v2, v[208:211] offset:58368
    v_add_u32 v2, 0x10000, v2
    ds_write_b128 v2, v[212:215] offset:0
    ds_write_b128 v2, v[216:219] offset:1024
    ds_write_b128 v2, v[220:223] offset:29696
    ds_write_b128 v2, v[224:227] offset:30720
    s_waitcnt lgkmcnt(0)
    v_mov_b32 v1, 77748
    v_mov_b32 v7, 1
    s_mov_b64 exec, 1
    ds_add_u32 v1, v7
    s_mov_b64 exec, -1
    v_mov_b32 v1, 77756
    s_mov_b32 s79, 1048576
k_gdone:
    ds_read_b32 v7, v1
    s_sub_u32 s79, s79, 1
    s_cbranch_scc1 k_gdone_x
    s_waitcnt lgkmcnt(0)
    v_readfirstlane_b32 s78, v7
    s_nop 1
    s_cmp_ge_u32 s78, 4
    s_cbranch_scc1 k_gdone_x
    s_sleep 1
    s_branch k_gdone
k_gdone_x:
    s_waitcnt lgkmcnt(0)
    buffer_store_dwordx4 v[56:59], v4, s[56:59], s76 offen offset:0 sc1
    buffer_store_dwordx4 v[60:63], v4, s[56:59], s76 offen offset:1024 sc1
    buffer_store_dwordx4 v[64:67], v4, s[56:59], s76 offen offset:2048 sc1
    buffer_store_dwordx4 v[68:71], v4, s[56:59], s76 offen offset:3072 sc1
    s_add_u32 s23, s23, 32768
    s_add_u32 s22, s22, 32768
    s_waitcnt vmcnt(0)
    v_mov_b32 v1, 77788
    v_mov_b32 v7, 1
    s_mov_b64 exec, 1
    ds_add_rtn_u32 v7, v1, v7
    s_mov_b64 exec, -1
    s_waitcnt lgkmcnt(0)
    v_readfirstlane_b32 s78, v7
    s_nop 1
    s_cmp_lg_u32 s78, 3
    s_cbranch_scc1 k_ysig
    v_mov_b32 v40, s53
    v_mov_b32 v41, s53
    v_mov_b32 v42, s53
    v_mov_b32 v43, s53
    s_mov_b64 exec, 0xff
    buffer_store_dwordx4 v[40:43], v5, s[56:59], s23 offen sc1
    s_mov_b64 exec, -1
k_ysig:
    s_cmp_ge_u32 s41, 2
    s_cbranch_scc1 k_sdone
    s_mov_b32 s4, s30
    s_mov_b32 s5, s31
    s_mov_b32 s6, 8388608
    s_mov_b32 s7, 0x20000
    v_lshrrev_b32 v1, 3, v0
    v_and_b32 v2, 7, v0
    v_mov_b32 v20, v1
    v_and_b32 v4, 15, v0
    v_lshlrev_b32 v4, 7, v4
    s_lshl_b32 s64, s68, 18
    s_lshl_b32 s65, s69, 8
    s_add_u32 s64, s64, s65
    s_lshl_b32 s65, s41, 7
    s_add_u32 s64, s64, s65
    s_add_u32 s64, s64, 4194304
    v_lshlrev_b32 v18, 15, v1
    v_lshl_add_u32 v18, v2, 4, v18
    s_lshl_b32 s66, s69, 19
    s_lshl_b32 s65, s41, 18
    s_add_u32 s66, s66, s65
    s_lshl_b32 s65, s68, 7
    s_add_u32 s66, s66, s65
    s_add_u32 s66, s66, 2048
    v_lshlrev_b32_e64 v19, 15, v2
    v_lshl_add_u32 v19, v1, 4, v19
    s_mov_b32 s70, 0x05040100
    s_mov_b32 s71, 0x07060302
    v_mov_b32 v1, 77760
    s_mov_b32 s79, 1048576
k_ygate:
    ds_read_b32 v7, v1
    s_sub_u32 s79, s79, 1
    s_cbranch_scc1 k_ygate_x
    s_waitcnt lgkmcnt(0)
    v_readfirstlane_b32 s78, v7
    s_nop 1
    s_cmp_ge_u32 s78, 4
    s_cbranch_scc1 k_ygate_x
    s_sleep 2
    s_branch k_ygate
k_ygate_x:
    s_waitcnt lgkmcnt(0)
    v_mov_b32 v1, 77792
    v_mov_b32 v7, 1
    s_mov_b64 exec, 1
    ds_add_rtn_u32 v7, v1, v7
    s_mov_b64 exec, -1
    s_waitcnt lgkmcnt(0)
    v_readfirstlane_b32 s78, v7
    s_nop 1
    s_cmp_lg_u32 s78, 1
    s_cbranch_scc1 k_ypoll_w
    s_mov_b32 s79, 1048576
    s_branch k_ypoll
k_ypoll_again:
    s_sleep 8
k_ypoll:
    buffer_load_dword v9, v4, s[56:59], s22 offen sc1
    s_sub_u32 s79, s79, 1
    s_cbranch_scc1 k_ypoll_x
    s_waitcnt vmcnt(0)
    v_cmp_ne_u32 vcc, s53, v9
    s_cbranch_vccnz k_ypoll_again
k_ypoll_x:
    s_waitcnt vmcnt(0)
    v_mov_b32 v1, 77792
    v_mov_b32 v7, 1
    s_mov_b64 exec, 1
    ds_add_u32 v1, v7
    s_mov_b64 exec, -1
k_ypoll_w:
    v_mov_b32 v1, 77792
    s_mov_b32 s79, 1048576
k_ypoll_l:
    ds_read_b32 v7, v1
    s_sub_u32 s79, s79, 1
    s_cbranch_scc1 k_ypoll_l_x
    s_waitcnt lgkmcnt(0)
    v_readfirstlane_b32 s78, v7
    s_nop 1
    s_cmp_ge_u32 s78, 3
    s_cbranch_scc1 k_ypoll_l_x
    s_branch k_ypoll_l
k_ypoll_l_x:
    s_waitcnt lgkmcnt(0)
    s_waitcnt vmcnt(0)
    s_nop 0
    buffer_load_dwordx4 v[24:27], v18, s[56:59], s64 offen sc1
    s_add_u32 s64, s64, 4096
    buffer_load_dwordx4 v[28:31], v18, s[56:59], s64 offen sc1
    s_add_u32 s64, s64, 4096
    buffer_load_dwordx4 v[32:35], v18, s[56:59], s64 offen sc1
    s_add_u32 s64, s64, 4096
    buffer_load_dwordx4 v[36:39], v18, s[56:59], s64 offen sc1
    s_add_u32 s64, s64, 4096
    buffer_load_dwordx4 v[40:43], v18, s[56:59], s64 offen sc1
    s_add_u32 s64, s64, 4096
    buffer_load_dwordx4 v[44:47], v18, s[56:59], s64 offen sc1
    s_add_u32 s64, s64, 4096
    buffer_load_dwordx4 v[48:51], v18, s[56:59], s64 offen sc1
    s_add_u32 s64, s64, 4096
    buffer_load_dwordx4 v[52:55], v18, s[56:59], s64 offen sc1
    s_waitcnt vmcnt(0)
    s_nop 0
    v_perm_b32 v56, v28, v24, s70
    v_perm_b32 v57, v36, v32, s70
    v_perm_b32 v58, v44, v40, s70
    v_perm_b32 v59, v52, v48, s70
    buffer_store_dwordx4 v[56:59], v19, s[4:7], s66 offen
    s_add_u32 s66, s66, 4096
    v_perm_b32 v60, v28, v24, s71
    v_perm_b32 v61, v36, v32, s71
    v_perm_b32 v62, v44, v40, s71
    v_perm_b32 v63, v52, v48, s71
    buffer_store_dwordx4 v[60:63], v19, s[4:7], s66 offen
    s_add_u32 s66, s66, 4096
    v_perm_b32 v64, v29, v25, s70
    v_perm_b32 v65, v37, v33, s70
    v_perm_b32 v66, v45, v41, s70
    v_perm_b32 v67, v53, v49, s70
    buffer_store_dwordx4 v[64:67], v19, s[4:7], s66 offen
    s_add_u32 s66, s66, 4096
    v_perm_b32 v68, v29, v25, s71
    v_perm_b32 v69, v37, v33, s71
    v_perm_b32 v70, v45, v41, s71
    v_perm_b32 v71, v53, v49, s71
    buffer_store_dwordx4 v[68:71], v19, s[4:7], s66 offen
    s_add_u32 s66, s66, 4096
    v_perm_b32 v72, v30, v26, s70
    v_perm_b32 v73, v38, v34, s70
    v_perm_b32 v74, v46, v42, s70
    v_perm_b32 v75, v54, v50, s70
    buffer_store_dwordx4 v[72:75], v19, s[4:7], s66 offen
    s_add_u32 s66, s66, 4096
    v_perm_b32 v76, v30, v26, s71
    v_perm_b32 v77, v38, v34, s71
    v_perm_b32 v78, v46, v42, s71
    v_perm_b32 v79, v54, v50, s71
    buffer_store_dwordx4 v[76:79], v19, s[4:7], s66 offen
    s_add_u32 s66, s66, 4096
    v_perm_b32 v80, v31, v27, s70
    v_perm_b32 v81, v39, v35, s70
    v_perm_b32 v82, v47, v43, s70
    v_perm_b32 v83, v55, v51, s70
    buffer_store_dwordx4 v[80:83], v19, s[4:7], s66 offen
    s_add_u32 s66, s66, 4096
    v_perm_b32 v84, v31, v27, s71
    v_perm_b32 v85, v39, v35, s71
    v_perm_b32 v86, v47, v43, s71
    v_perm_b32 v87, v55, v51, s71
    buffer_store_dwordx4 v[84:87], v19, s[4:7], s66 offen
k_sdone:
k_end:
    s_endpgm
k_last:
.section .rodata,"a"
.p2align 6
.amdhsa_kernel concat_heads__linear_kernel_hedgehog__ssm_conv_s4__prompt_kernel
  .amdhsa_next_free_vgpr 256
  .amdhsa_next_free_sgpr 102
  .amdhsa_accum_offset 256
  .amdhsa_group_segment_fixed_size 0
  .amdhsa_kernarg_size 128
  .amdhsa_user_sgpr_count 2
  .amdhsa_user_sgpr_kernarg_segment_ptr 1
  .amdhsa_system_sgpr_workgroup_id_x 1
  .amdhsa_float_denorm_mode_32 3
.end_amdhsa_kernel
```
